```python
import torch

def _softmax(x, axis=-1):
    return torch.softmax(x, dim=axis)
def _gelu(x):
    return torch.nn.functional.gelu(x, approximate="tanh")
def _silu(x):
    return torch.nn.functional.silu(x)
def _sigmoid(x):
    return torch.sigmoid(x)
def _layernorm(x, axis=-1, eps=1e-5):
    m = x.mean(dim=axis, keepdim=True)
    v = x.var(dim=axis, keepdim=True, unbiased=False)
    return (x - m) / torch.sqrt(v + eps)
def _scatter_add(tgt, idx, src, axis=0):
    return tgt.clone().index_add_(axis, idx, src)
def _segment_sum(src, seg, n):
    out = torch.zeros((n,) + src.shape[1:], dtype=src.dtype)
    return out.index_add_(0, seg, src)
def _pad(x, pw):
    flat = tuple(v for pair in reversed(pw) for v in pair)
    return torch.nn.functional.pad(x, flat)

kernel_name = 'parallel_sum__sliding_block_cached__swiglu_ffn__decode'

def setup_inputs():

    _w = (lambda a: (lambda t: t.to(torch.bfloat16) if t.is_floating_point() else t)(torch.as_tensor(a)))
    def _A_setup():
        B, Sq, D = 4, 1, 448
        Hq, Hkv, Sk, Dh = 16, 8, 16384, 256
        assert Hq % Hkv == 0, (Hq, Hkv)
        return {
            "x": _w((lambda *s: torch.randn(*s, dtype=torch.bfloat16) * 0.05)(B, Sq, D)),
            "k_cache": _w((lambda *s: torch.randn(*s, dtype=torch.bfloat16) * 3.2)(B, Hkv, Sk, Dh)),
            "v_cache": _w((lambda *s: torch.randn(*s, dtype=torch.bfloat16) * 1.6)(B, Hkv, Sk, Dh)),
            "wq": _w((lambda *s: torch.randn(*s, dtype=torch.bfloat16) * 3.2)(D, Hq * Dh) * (D ** -0.5)),
            "wo": _w((lambda *s: torch.randn(*s, dtype=torch.bfloat16) * 1.6)(Hq * Dh, D) * ((Hq * Dh) ** -0.5)),
        }
    _A_in = _A_setup()

    def _B_setup():
        B, S, D, F = 4, 1, 448, 1792
        return {
            "x": _w((lambda *s: torch.randn(*s, dtype=torch.bfloat16) * 0.05)(B, S, D)),
            "w_gate": _w((lambda *s: torch.randn(*s, dtype=torch.bfloat16) * 0.05)(D, F)),
            "w_up": _w((lambda *s: torch.randn(*s, dtype=torch.bfloat16) * 0.05)(D, F)),
            "w_down": _w((lambda *s: torch.randn(*s, dtype=torch.bfloat16) * 0.05)(F, D)),
        }
    _B_in = _B_setup()

    return {
        "A_x": _A_in["x"],
        "A_k_cache": _A_in["k_cache"],
        "A_v_cache": _A_in["v_cache"],
        "A_wq": _A_in["wq"],
        "A_wo": _A_in["wo"],
        "B_x": _B_in["x"],
        "B_w_gate": _B_in["w_gate"],
        "B_w_up": _B_in["w_up"],
        "B_w_down": _B_in["w_down"],
    }

def reference(A_x, A_k_cache, A_v_cache, A_wq, A_wo, B_x, B_w_gate, B_w_up, B_w_down):
    def _A_ref(x, k_cache, v_cache, wq, wo):
        B, Sq, D = x.shape
        Hq, Dh = 16, 256
        Hkv, Sk = k_cache.shape[1], k_cache.shape[2]
        W = min(4096, max(256, Sk // 4))
        rep = Hq // Hkv
        q = (lambda x, *d: x.permute(*d))((x @ wq).reshape(B, Sq, Hq, Dh), 0, 2, 1, 3)
        k = (lambda x, n, axis: torch.repeat_interleave(x, n, dim=axis))(k_cache[:, :, Sk - W:, :], rep, axis=1)
        v = (lambda x, n, axis: torch.repeat_interleave(x, n, dim=axis))(v_cache[:, :, Sk - W:, :], rep, axis=1)
        scores = torch.einsum("bhqd,bhkd->bhqk", q, k) * (Dh ** -0.5)
        p = _softmax(scores, axis=-1)
        o = torch.einsum("bhqk,bhkd->bhqd", p, v)
        return (lambda x, *d: x.permute(*d))(o, 0, 2, 1, 3).reshape(B, Sq, Hq * Dh) @ wo

    def _B_ref(x, w_gate, w_up, w_down):
        g = _silu(x @ w_gate)
        u = x @ w_up
        return (g * u) @ w_down

    x = A_x
    xn = _layernorm(x, axis=-1)
    return x + _A_ref(xn, A_k_cache, A_v_cache, A_wq, A_wo) + _B_ref(xn, B_w_gate, B_w_up, B_w_down)
```

```asm
; @launch grid=(256,1,1) block=(512,1,1) lds=43008
.amdgcn_target "amdgcn-amd-amdhsa--gfx950"
.text
.globl parallel_sum__sliding_block_cached__swiglu_ffn__decode_kernel
.p2align 8
.type parallel_sum__sliding_block_cached__swiglu_ffn__decode_kernel,@function
parallel_sum__sliding_block_cached__swiglu_ffn__decode_kernel:
    s_load_dwordx16 s[8:23], s[0:1], 0
    s_load_dwordx8 s[24:31], s[0:1], 64
    s_cmpk_ge_u32 s2, 256
    s_cbranch_scc1 L_end
    v_lshrrev_b32 v1, 6, v0
    v_and_b32 v0, 63, v0
    v_readfirstlane_b32 s3, v1
    v_and_b32 v2, 15, v0
    v_lshrrev_b32 v3, 4, v0
    s_cmp_lt_u32 s3, 4
    s_cbranch_scc0 L_stream
L_helper:
    s_setprio 3
    s_and_b32 s4, s2, 7
    s_lshr_b32 s5, s2, 3
    s_lshl_b32 s6, s5, 2
    s_add_u32 s6, s6, s3
    s_cmp_lg_u32 s6, 65
    s_cbranch_scc1 L_npf
    s_getpc_b64 s[36:37]
L_pc:
    s_mov_b32 s38, L_codeend-L_pc
    s_mov_b32 s39, 0x20000
    s_movk_i32 s6, 8192
    v_lshlrev_b32 v4, 7, v0
    buffer_load_dword v63, v4, s[36:39], 0 offen
    v_add_u32 v4, s6, v4
    buffer_load_dword v63, v4, s[36:39], 0 offen
L_npf:
    s_cmp_lg_u32 s3, 0
    s_cbranch_scc1 L_h123n
    v_mul_u32_u24 v4, 896, v3
    v_lshl_add_u32 v4, v2, 3, v4
    v_lshrrev_b32 v5, 3, v0
    v_and_b32 v6, 7, v0
    v_and_b32 v7, 2, v5
    v_xor_b32 v6, v6, v7
    v_lshlrev_b32 v6, 4, v6
    s_mov_b32 m0, 0
    s_mov_b32 s39, 0x20000
    s_cmpk_ge_u32 s2, 240
    s_cbranch_scc1 L_h123n
    s_cmpk_ge_u32 s2, 128
    s_cbranch_scc1 L_tf
    s_movk_i32 s50, 8192
    s_lshr_b32 s54, s5, 3
    s_and_b32 s51, s5, 7
    s_add_u32 s55, s4, s5
    s_and_b32 s55, s55, 7
    s_lshl_b32 s52, s55, 3
    s_add_u32 s52, s52, s51
    s_lshl_b32 s52, s52, 7
    s_lshl_b32 s53, s55, 12
    s_lshl_b32 s51, s51, 8
    s_add_u32 s53, s53, s51
    s_lshl_b32 s51, s54, 11
    s_add_u32 s53, s53, s51
    s_add_u32 s53, s53, 65536
    v_and_b32 v8, 3, v2
    v_lshlrev_b32 v8, 15, v8
    v_lshrrev_b32 v9, 2, v2
    v_lshl_add_u32 v8, v9, 6, v8
    v_lshl_add_u32 v60, v3, 4, v8
    s_waitcnt lgkmcnt(0)
    s_mov_b64 s[36:37], s[14:15]
    s_branch L_tg
L_tf:
    s_movk_i32 s50, 3584
    s_bfe_u32 s54, s2, 0x10001
    s_bfe_u32 s51, s2, 0x50002
    s_lshl_b32 s52, s51, 7
    s_lshl_b32 s53, s51, 12
    s_and_b32 s51, s2, 1
    s_lshl_b32 s51, s51, 8
    s_add_u32 s53, s53, s51
    s_lshl_b32 s51, s54, 7
    s_add_u32 s53, s53, s51
    s_add_u32 s53, s53, 196608
    v_and_b32 v8, 3, v2
    v_lshlrev_b32 v8, 5, v8
    v_lshrrev_b32 v9, 2, v2
    v_lshl_add_u32 v8, v9, 10, v8
    v_lshrrev_b32 v9, 1, v3
    v_lshl_add_u32 v8, v9, 9, v8
    v_and_b32 v9, 1, v3
    v_lshl_add_u32 v60, v9, 4, v8
    s_bitcmp1_b32 s2, 0
    s_waitcnt lgkmcnt(0)
    s_cselect_b64 s[36:37], s[22:23], s[20:21]
L_tg:
    s_mul_i32 s38, s50, 448
    s_mul_i32 s51, s50, 224
    s_mul_i32 s51, s51, s54
    s_add_u32 s52, s52, s51
    v_mul_u32_u24 v5, s50, v5
    s_lshl_b32 s50, s50, 3
    v_add_u32 v5, v5, v6
    v_xor_b32 v6, 64, v5
    s_mov_b32 s32, s8
    s_mov_b32 s33, s9
    s_mov_b32 s34, 3584
    s_mov_b32 s35, 0x20000
    buffer_load_dwordx2 v[64:65], v4, s[32:35], 0 offen offset:0
    buffer_load_dwordx2 v[66:67], v4, s[32:35], 0 offen offset:128
    buffer_load_dwordx2 v[68:69], v4, s[32:35], 0 offen offset:256
    buffer_load_dwordx2 v[70:71], v4, s[32:35], 0 offen offset:384
    buffer_load_dwordx2 v[72:73], v4, s[32:35], 0 offen offset:512
    buffer_load_dwordx2 v[74:75], v4, s[32:35], 0 offen offset:640
    buffer_load_dwordx2 v[76:77], v4, s[32:35], 0 offen offset:768
L_dma:
    buffer_load_dwordx4 v5, s[36:39], s52 offen nt lds
    s_add_u32 m0, m0, 1024
    s_add_u32 s52, s52, s50
    buffer_load_dwordx4 v6, s[36:39], s52 offen nt lds
    s_add_u32 m0, m0, 1024
    s_add_u32 s52, s52, s50
    s_cmp_lt_u32 m0, 28672
    s_cbranch_scc1 L_dma
    s_barrier
    s_branch L_ln
L_h123n:
    s_barrier
    s_branch L_h123
L_stream:
    s_and_b32 s4, s2, 31
    s_lshl_b32 s4, s4, 23
    s_lshr_b32 s5, s2, 5
    s_lshl_b32 s5, s5, 18
    s_add_u32 s4, s4, s5
    s_lshl_b32 s5, s3, 11
    s_add_u32 s4, s4, s5
    s_add_u32 s4, s4, 6283264
    s_lshr_b32 s6, s2, 3
    s_lshl_b32 s6, s6, 13
    v_lshlrev_b32 v1, 4, v2
    v_lshl_add_u32 v1, v3, 9, v1
    s_mov_b32 s34, 0x40000
    s_mov_b32 s35, 0x20000
    s_mov_b32 s38, 0x40000
    s_mov_b32 s39, 0x20000
    s_waitcnt lgkmcnt(0)
    s_add_u32 s32, s10, s4
    s_addc_u32 s33, s11, 0
    s_add_u32 s36, s12, s4
    s_addc_u32 s37, s13, 0
    s_getreg_b32 s62, hwreg(20,0,3)
    s_lshl_b32 s62, s62, 2
    s_lshr_b32 s62, 0x30303030, s62
    s_barrier
    buffer_load_dwordx4 v[64:67], v1, s[32:35], s6 offen offset:0 nt
    buffer_load_dwordx4 v[68:71], v1, s[32:35], s6 offen offset:256 nt
    s_add_u32 s6, s6, 0x2000
    s_and_b32 s6, s6, 0x3ffff
    buffer_load_dwordx4 v[72:75], v1, s[32:35], s6 offen offset:0 nt
    buffer_load_dwordx4 v[76:79], v1, s[32:35], s6 offen offset:256 nt
    s_add_u32 s6, s6, 0x2000
    s_and_b32 s6, s6, 0x3ffff
    s_load_dword s7, s[30:31], 0
    v_lshrrev_b32 v4, 3, v2
    v_lshlrev_b32 v4, 9, v4
    v_lshl_add_u32 v4, v2, 4, v4
    v_xor_b32 v5, 0x200, v4
    buffer_load_dwordx4 v[80:83], v1, s[32:35], s6 offen offset:0 nt
    s_bitcmp1_b32 s62, 1
    s_cbranch_scc1 L_th5
    s_waitcnt vmcnt(5)
L_th5:
    buffer_load_dwordx4 v[84:87], v1, s[32:35], s6 offen offset:256 nt
    s_add_u32 s6, s6, 0x2000
    s_and_b32 s6, s6, 0x3ffff
    s_bitcmp1_b32 s62, 0
    s_cbranch_scc1 L_th6
    s_waitcnt vmcnt(5)
L_th6:
    buffer_load_dwordx4 v[88:91], v1, s[32:35], s6 offen offset:0 nt
    s_bitcmp1_b32 s62, 1
    s_cbranch_scc1 L_th7
    s_waitcnt vmcnt(5)
L_th7:
    buffer_load_dwordx4 v[92:95], v1, s[32:35], s6 offen offset:256 nt
    s_add_u32 s6, s6, 0x2000
    s_and_b32 s6, s6, 0x3ffff
    s_waitcnt vmcnt(7)
    s_bitcmp1_b32 s62, 0
    s_cbranch_scc1 L_th8
    s_waitcnt vmcnt(5)
L_th8:
    buffer_load_dwordx4 v[96:99], v1, s[32:35], s6 offen offset:0 nt
    s_waitcnt vmcnt(7)
    s_bitcmp1_b32 s62, 1
    s_cbranch_scc1 L_th9
    s_waitcnt vmcnt(5)
L_th9:
    buffer_load_dwordx4 v[100:103], v1, s[32:35], s6 offen offset:256 nt
    s_add_u32 s6, s6, 0x2000
    s_and_b32 s6, s6, 0x3ffff
    s_waitcnt vmcnt(7)
    s_bitcmp1_b32 s62, 0
    s_cbranch_scc1 L_th10
    s_waitcnt vmcnt(5)
L_th10:
    buffer_load_dwordx4 v[104:107], v1, s[32:35], s6 offen offset:0 nt
    s_waitcnt vmcnt(7)
    s_bitcmp1_b32 s62, 1
    s_cbranch_scc1 L_th11
    s_waitcnt vmcnt(5)
L_th11:
    buffer_load_dwordx4 v[108:111], v1, s[32:35], s6 offen offset:256 nt
    s_add_u32 s6, s6, 0x2000
    s_and_b32 s6, s6, 0x3ffff
    s_waitcnt vmcnt(7)
    s_bitcmp1_b32 s62, 0
    s_cbranch_scc1 L_th12
    s_waitcnt vmcnt(5)
L_th12:
    buffer_load_dwordx4 v[112:115], v1, s[32:35], s6 offen offset:0 nt
    s_waitcnt vmcnt(7)
    s_bitcmp1_b32 s62, 1
    s_cbranch_scc1 L_th13
    s_waitcnt vmcnt(5)
L_th13:
    buffer_load_dwordx4 v[116:119], v1, s[32:35], s6 offen offset:256 nt
    s_add_u32 s6, s6, 0x2000
    s_and_b32 s6, s6, 0x3ffff
    s_waitcnt vmcnt(7)
    s_bitcmp1_b32 s62, 0
    s_cbranch_scc1 L_th14
    s_waitcnt vmcnt(5)
L_th14:
    buffer_load_dwordx4 v[120:123], v1, s[32:35], s6 offen offset:0 nt
    s_waitcnt vmcnt(7)
    s_bitcmp1_b32 s62, 1
    s_cbranch_scc1 L_th15
    s_waitcnt vmcnt(5)
L_th15:
    buffer_load_dwordx4 v[124:127], v1, s[32:35], s6 offen offset:256 nt
    s_add_u32 s6, s6, 0x2000
    s_and_b32 s6, s6, 0x3ffff
    s_waitcnt vmcnt(7)
    s_bitcmp1_b32 s62, 0
    s_cbranch_scc1 L_th16
    s_waitcnt vmcnt(5)
L_th16:
    buffer_load_dwordx4 v[128:131], v1, s[32:35], s6 offen offset:0 nt
    s_waitcnt vmcnt(7)
    s_bitcmp1_b32 s62, 1
    s_cbranch_scc1 L_th17
    s_waitcnt vmcnt(5)
L_th17:
    buffer_load_dwordx4 v[132:135], v1, s[32:35], s6 offen offset:256 nt
    s_add_u32 s6, s6, 0x2000
    s_and_b32 s6, s6, 0x3ffff
    s_waitcnt vmcnt(7)
    s_bitcmp1_b32 s62, 0
    s_cbranch_scc1 L_th18
    s_waitcnt vmcnt(5)
L_th18:
    buffer_load_dwordx4 v[136:139], v1, s[32:35], s6 offen offset:0 nt
    s_waitcnt vmcnt(7)
    s_bitcmp1_b32 s62, 1
    s_cbranch_scc1 L_th19
    s_waitcnt vmcnt(5)
L_th19:
    buffer_load_dwordx4 v[140:143], v1, s[32:35], s6 offen offset:256 nt
    s_add_u32 s6, s6, 0x2000
    s_and_b32 s6, s6, 0x3ffff
    s_waitcnt vmcnt(7)
    s_bitcmp1_b32 s62, 0
    s_cbranch_scc1 L_th20
    s_waitcnt vmcnt(5)
L_th20:
    buffer_load_dwordx4 v[144:147], v1, s[32:35], s6 offen offset:0 nt
    s_waitcnt vmcnt(7)
    s_bitcmp1_b32 s62, 1
    s_cbranch_scc1 L_th21
    s_waitcnt vmcnt(5)
L_th21:
    buffer_load_dwordx4 v[148:151], v1, s[32:35], s6 offen offset:256 nt
    s_add_u32 s6, s6, 0x2000
    s_and_b32 s6, s6, 0x3ffff
    s_waitcnt vmcnt(7)
    s_bitcmp1_b32 s62, 0
    s_cbranch_scc1 L_th22
    s_waitcnt vmcnt(5)
L_th22:
    buffer_load_dwordx4 v[152:155], v1, s[32:35], s6 offen offset:0 nt
    s_waitcnt vmcnt(7)
    s_bitcmp1_b32 s62, 1
    s_cbranch_scc1 L_th23
    s_waitcnt vmcnt(5)
L_th23:
    buffer_load_dwordx4 v[156:159], v1, s[32:35], s6 offen offset:256 nt
    s_add_u32 s6, s6, 0x2000
    s_and_b32 s6, s6, 0x3ffff
    s_barrier
    s_waitcnt vmcnt(7)
    s_bitcmp1_b32 s62, 0
    s_cbranch_scc1 L_th24
    s_waitcnt vmcnt(5)
L_th24:
    buffer_load_dwordx4 v[160:163], v1, s[32:35], s6 offen offset:0 nt
    s_waitcnt vmcnt(7)
    s_bitcmp1_b32 s62, 1
    s_cbranch_scc1 L_th25
    s_waitcnt vmcnt(5)
L_th25:
    buffer_load_dwordx4 v[164:167], v1, s[32:35], s6 offen offset:256 nt
    s_add_u32 s6, s6, 0x2000
    s_and_b32 s6, s6, 0x3ffff
    s_waitcnt vmcnt(7)
    s_bitcmp1_b32 s62, 0
    s_cbranch_scc1 L_th26
    s_waitcnt vmcnt(5)
L_th26:
    buffer_load_dwordx4 v[168:171], v1, s[32:35], s6 offen offset:0 nt
    s_waitcnt vmcnt(7)
    s_bitcmp1_b32 s62, 1
    s_cbranch_scc1 L_th27
    s_waitcnt vmcnt(5)
L_th27:
    buffer_load_dwordx4 v[172:175], v1, s[32:35], s6 offen offset:256 nt
    s_add_u32 s6, s6, 0x2000
    s_and_b32 s6, s6, 0x3ffff
    s_waitcnt vmcnt(7)
    s_bitcmp1_b32 s62, 0
    s_cbranch_scc1 L_th28
    s_waitcnt vmcnt(5)
L_th28:
    buffer_load_dwordx4 v[176:179], v1, s[32:35], s6 offen offset:0 nt
    s_waitcnt vmcnt(7)
    s_bitcmp1_b32 s62, 1
    s_cbranch_scc1 L_th29
    s_waitcnt vmcnt(5)
L_th29:
    buffer_load_dwordx4 v[180:183], v1, s[32:35], s6 offen offset:256 nt
    s_add_u32 s6, s6, 0x2000
    s_and_b32 s6, s6, 0x3ffff
    s_waitcnt vmcnt(7)
    s_bitcmp1_b32 s62, 0
    s_cbranch_scc1 L_th30
    s_waitcnt vmcnt(5)
L_th30:
    buffer_load_dwordx4 v[184:187], v1, s[32:35], s6 offen offset:0 nt
    s_waitcnt vmcnt(7)
    s_bitcmp1_b32 s62, 1
    s_cbranch_scc1 L_th31
    s_waitcnt vmcnt(5)
L_th31:
    buffer_load_dwordx4 v[188:191], v1, s[32:35], s6 offen offset:256 nt
    s_add_u32 s6, s6, 0x2000
    s_and_b32 s6, s6, 0x3ffff
    s_waitcnt vmcnt(7)
    s_bitcmp1_b32 s62, 0
    s_cbranch_scc1 L_th32
    s_waitcnt vmcnt(5)
L_th32:
    buffer_load_dwordx4 v[192:195], v1, s[32:35], s6 offen offset:0 nt
    s_waitcnt vmcnt(7)
    s_bitcmp1_b32 s62, 1
    s_cbranch_scc1 L_th33
    s_waitcnt vmcnt(5)
L_th33:
    buffer_load_dwordx4 v[196:199], v1, s[32:35], s6 offen offset:256 nt
    s_add_u32 s6, s6, 0x2000
    s_and_b32 s6, s6, 0x3ffff
    s_waitcnt vmcnt(7)
    s_bitcmp1_b32 s62, 0
    s_cbranch_scc1 L_th34
    s_waitcnt vmcnt(5)
L_th34:
    buffer_load_dwordx4 v[200:203], v1, s[32:35], s6 offen offset:0 nt
    s_waitcnt vmcnt(7)
    s_bitcmp1_b32 s62, 1
    s_cbranch_scc1 L_th35
    s_waitcnt vmcnt(5)
L_th35:
    buffer_load_dwordx4 v[204:207], v1, s[32:35], s6 offen offset:256 nt
    s_add_u32 s6, s6, 0x2000
    s_and_b32 s6, s6, 0x3ffff
    s_waitcnt vmcnt(7)
    s_bitcmp1_b32 s62, 0
    s_cbranch_scc1 L_th36
    s_waitcnt vmcnt(5)
L_th36:
    buffer_load_dwordx4 v[208:211], v1, s[32:35], s6 offen offset:0 nt
    s_waitcnt vmcnt(7)
    s_bitcmp1_b32 s62, 1
    s_cbranch_scc1 L_th37
    s_waitcnt vmcnt(5)
L_th37:
    buffer_load_dwordx4 v[212:215], v1, s[32:35], s6 offen offset:256 nt
    s_add_u32 s6, s6, 0x2000
    s_and_b32 s6, s6, 0x3ffff
    s_waitcnt vmcnt(7)
    s_bitcmp1_b32 s62, 0
    s_cbranch_scc1 L_th38
    s_waitcnt vmcnt(5)
L_th38:
    buffer_load_dwordx4 v[216:219], v1, s[32:35], s6 offen offset:0 nt
    s_waitcnt vmcnt(7)
    s_bitcmp1_b32 s62, 1
    s_cbranch_scc1 L_th39
    s_waitcnt vmcnt(5)
L_th39:
    buffer_load_dwordx4 v[220:223], v1, s[32:35], s6 offen offset:256 nt
    s_add_u32 s6, s6, 0x2000
    s_and_b32 s6, s6, 0x3ffff
    s_waitcnt vmcnt(7)
    s_bitcmp1_b32 s62, 0
    s_cbranch_scc1 L_th40
    s_waitcnt vmcnt(5)
L_th40:
    buffer_load_dwordx4 v[224:227], v1, s[32:35], s6 offen offset:0 nt
    s_waitcnt vmcnt(7)
    s_bitcmp1_b32 s62, 1
    s_cbranch_scc1 L_th41
    s_waitcnt vmcnt(5)
L_th41:
    buffer_load_dwordx4 v[228:231], v1, s[32:35], s6 offen offset:256 nt
    s_add_u32 s6, s6, 0x2000
    s_and_b32 s6, s6, 0x3ffff
    s_waitcnt vmcnt(7)
    s_bitcmp1_b32 s62, 0
    s_cbranch_scc1 L_th42
    s_waitcnt vmcnt(5)
L_th42:
    buffer_load_dwordx4 v[232:235], v1, s[32:35], s6 offen offset:0 nt
    s_waitcnt vmcnt(7)
    s_bitcmp1_b32 s62, 1
    s_cbranch_scc1 L_th43
    s_waitcnt vmcnt(5)
L_th43:
    buffer_load_dwordx4 v[236:239], v1, s[32:35], s6 offen offset:256 nt
    s_add_u32 s6, s6, 0x2000
    s_and_b32 s6, s6, 0x3ffff
    s_waitcnt vmcnt(7)
    s_bitcmp1_b32 s62, 0
    s_cbranch_scc1 L_th44
    s_waitcnt vmcnt(5)
L_th44:
    buffer_load_dwordx4 v[240:243], v1, s[32:35], s6 offen offset:0 nt
    s_waitcnt vmcnt(7)
    s_bitcmp1_b32 s62, 1
    s_cbranch_scc1 L_th45
    s_waitcnt vmcnt(5)
L_th45:
    buffer_load_dwordx4 v[244:247], v1, s[32:35], s6 offen offset:256 nt
    s_add_u32 s6, s6, 0x2000
    s_and_b32 s6, s6, 0x3ffff
    s_waitcnt vmcnt(7)
    s_bitcmp1_b32 s62, 0
    s_cbranch_scc1 L_th46
    s_waitcnt vmcnt(5)
L_th46:
    buffer_load_dwordx4 v[248:251], v1, s[32:35], s6 offen offset:0 nt
    s_waitcnt vmcnt(7)
    s_bitcmp1_b32 s62, 1
    s_cbranch_scc1 L_th47
    s_waitcnt vmcnt(5)
L_th47:
    buffer_load_dwordx4 v[252:255], v1, s[32:35], s6 offen offset:256 nt
    s_add_u32 s6, s6, 0x2000
    s_and_b32 s6, s6, 0x3ffff
    s_waitcnt lgkmcnt(0)
    s_barrier
    ds_read_b128 v[8:11], v4 offset:32256
    ds_read_b128 v[12:15], v4 offset:32512
    ds_read_b128 v[16:19], v5 offset:32256
    ds_read_b128 v[20:23], v5 offset:32512
    s_add_u32 s7, s7, 1
    s_waitcnt lgkmcnt(0)
    v_mov_b32 v4, 0
    v_mov_b32 v5, 0
    s_waitcnt vmcnt(47)
    v_dot2c_f32_bf16 v4, v64, v8
    v_dot2c_f32_bf16 v5, v64, v16
    v_dot2c_f32_bf16 v4, v65, v9
    v_dot2c_f32_bf16 v5, v65, v17
    v_dot2c_f32_bf16 v4, v66, v10
    v_dot2c_f32_bf16 v5, v66, v18
    v_dot2c_f32_bf16 v4, v67, v11
    v_dot2c_f32_bf16 v5, v67, v19
    s_waitcnt vmcnt(46)
    v_dot2c_f32_bf16 v4, v68, v12
    v_dot2c_f32_bf16 v5, v68, v20
    v_dot2c_f32_bf16 v4, v69, v13
    v_dot2c_f32_bf16 v5, v69, v21
    v_dot2c_f32_bf16 v4, v70, v14
    v_dot2c_f32_bf16 v5, v70, v22
    v_dot2c_f32_bf16 v4, v71, v15
    v_dot2c_f32_bf16 v5, v71, v23
    v_mov_b32 v6, 0
    v_mov_b32 v7, 0
    s_waitcnt vmcnt(45)
    v_dot2c_f32_bf16 v6, v72, v8
    v_dot2c_f32_bf16 v7, v72, v16
    v_dot2c_f32_bf16 v6, v73, v9
    v_dot2c_f32_bf16 v7, v73, v17
    v_add_f32_dpp v24, v5, v4 row_ror:8 row_mask:0xf bank_mask:0xf
    v_dot2c_f32_bf16 v6, v74, v10
    v_dot2c_f32_bf16 v7, v74, v18
    v_add_f32_dpp v24, v24, v24 row_half_mirror row_mask:0xf bank_mask:0xf
    v_dot2c_f32_bf16 v6, v75, v11
    v_dot2c_f32_bf16 v7, v75, v19
    v_add_f32_dpp v24, v24, v24 quad_perm:[1,0,3,2] row_mask:0xf bank_mask:0xf
    s_waitcnt vmcnt(44)
    v_dot2c_f32_bf16 v6, v76, v12
    v_dot2c_f32_bf16 v7, v76, v20
    v_add_f32_dpp v24, v24, v24 quad_perm:[2,3,0,1] row_mask:0xf bank_mask:0xf
    v_dot2c_f32_bf16 v6, v77, v13
    v_dot2c_f32_bf16 v7, v77, v21
    v_cvt_pk_bf16_f32 v24, v24, v24
    v_dot2c_f32_bf16 v6, v78, v14
    v_dot2c_f32_bf16 v7, v78, v22
    v_and_b32 v24, 0xffff0000, v24
    v_dot2c_f32_bf16 v6, v79, v15
    v_dot2c_f32_bf16 v7, v79, v23
    s_bitcmp1_b32 s62, 0
    s_cbranch_scc1 L_th48
    s_waitcnt vmcnt(5)
L_th48:
    buffer_load_dwordx4 v[64:67], v1, s[32:35], s6 offen offset:0 nt
    v_mov_b32 v4, 0
    v_mov_b32 v5, 0
    s_waitcnt vmcnt(44)
    v_dot2c_f32_bf16 v4, v80, v8
    v_dot2c_f32_bf16 v5, v80, v16
    v_dot2c_f32_bf16 v4, v81, v9
    v_dot2c_f32_bf16 v5, v81, v17
    v_add_f32_dpp v25, v7, v6 row_ror:8 row_mask:0xf bank_mask:0xf
    v_dot2c_f32_bf16 v4, v82, v10
    v_dot2c_f32_bf16 v5, v82, v18
    v_add_f32_dpp v25, v25, v25 row_half_mirror row_mask:0xf bank_mask:0xf
    v_dot2c_f32_bf16 v4, v83, v11
    v_dot2c_f32_bf16 v5, v83, v19
    v_add_f32_dpp v25, v25, v25 quad_perm:[1,0,3,2] row_mask:0xf bank_mask:0xf
    s_waitcnt vmcnt(43)
    v_dot2c_f32_bf16 v4, v84, v12
    v_dot2c_f32_bf16 v5, v84, v20
    v_add_f32_dpp v25, v25, v25 quad_perm:[2,3,0,1] row_mask:0xf bank_mask:0xf
    v_dot2c_f32_bf16 v4, v85, v13
    v_dot2c_f32_bf16 v5, v85, v21
    v_cvt_pk_bf16_f32 v25, v25, v25
    v_dot2c_f32_bf16 v4, v86, v14
    v_dot2c_f32_bf16 v5, v86, v22
    v_and_b32 v25, 0xffff0000, v25
    v_dot2c_f32_bf16 v4, v87, v15
    v_dot2c_f32_bf16 v5, v87, v23
    v_mov_b32 v6, 0
    v_mov_b32 v7, 0
    s_waitcnt vmcnt(42)
    v_dot2c_f32_bf16 v6, v88, v8
    v_dot2c_f32_bf16 v7, v88, v16
    v_dot2c_f32_bf16 v6, v89, v9
    v_dot2c_f32_bf16 v7, v89, v17
    v_add_f32_dpp v26, v5, v4 row_ror:8 row_mask:0xf bank_mask:0xf
    v_dot2c_f32_bf16 v6, v90, v10
    v_dot2c_f32_bf16 v7, v90, v18
    v_add_f32_dpp v26, v26, v26 row_half_mirror row_mask:0xf bank_mask:0xf
    v_dot2c_f32_bf16 v6, v91, v11
    v_dot2c_f32_bf16 v7, v91, v19
    v_add_f32_dpp v26, v26, v26 quad_perm:[1,0,3,2] row_mask:0xf bank_mask:0xf
    s_waitcnt vmcnt(41)
    v_dot2c_f32_bf16 v6, v92, v12
    v_dot2c_f32_bf16 v7, v92, v20
    v_add_f32_dpp v26, v26, v26 quad_perm:[2,3,0,1] row_mask:0xf bank_mask:0xf
    v_dot2c_f32_bf16 v6, v93, v13
    v_dot2c_f32_bf16 v7, v93, v21
    v_cvt_pk_bf16_f32 v26, v26, v26
    v_dot2c_f32_bf16 v6, v94, v14
    v_dot2c_f32_bf16 v7, v94, v22
    v_and_b32 v26, 0xffff0000, v26
    v_dot2c_f32_bf16 v6, v95, v15
    v_dot2c_f32_bf16 v7, v95, v23
    s_bitcmp1_b32 s62, 1
    s_cbranch_scc1 L_th49
    s_waitcnt vmcnt(5)
L_th49:
    buffer_load_dwordx4 v[68:71], v1, s[32:35], s6 offen offset:256 nt
    s_add_u32 s6, s6, 0x2000
    s_and_b32 s6, s6, 0x3ffff
    v_mov_b32 v4, 0
    v_mov_b32 v5, 0
    s_waitcnt vmcnt(41)
    v_dot2c_f32_bf16 v4, v96, v8
    v_dot2c_f32_bf16 v5, v96, v16
    v_dot2c_f32_bf16 v4, v97, v9
    v_dot2c_f32_bf16 v5, v97, v17
    v_add_f32_dpp v27, v7, v6 row_ror:8 row_mask:0xf bank_mask:0xf
    v_dot2c_f32_bf16 v4, v98, v10
    v_dot2c_f32_bf16 v5, v98, v18
    v_add_f32_dpp v27, v27, v27 row_half_mirror row_mask:0xf bank_mask:0xf
    v_dot2c_f32_bf16 v4, v99, v11
    v_dot2c_f32_bf16 v5, v99, v19
    v_add_f32_dpp v27, v27, v27 quad_perm:[1,0,3,2] row_mask:0xf bank_mask:0xf
    s_waitcnt vmcnt(40)
    v_dot2c_f32_bf16 v4, v100, v12
    v_dot2c_f32_bf16 v5, v100, v20
    v_add_f32_dpp v27, v27, v27 quad_perm:[2,3,0,1] row_mask:0xf bank_mask:0xf
    v_dot2c_f32_bf16 v4, v101, v13
    v_dot2c_f32_bf16 v5, v101, v21
    v_cvt_pk_bf16_f32 v27, v27, v27
    v_dot2c_f32_bf16 v4, v102, v14
    v_dot2c_f32_bf16 v5, v102, v22
    v_and_b32 v27, 0xffff0000, v27
    v_dot2c_f32_bf16 v4, v103, v15
    v_dot2c_f32_bf16 v5, v103, v23
    v_mov_b32 v6, 0
    v_mov_b32 v7, 0
    s_waitcnt vmcnt(39)
    v_dot2c_f32_bf16 v6, v104, v8
    v_dot2c_f32_bf16 v7, v104, v16
    v_dot2c_f32_bf16 v6, v105, v9
    v_dot2c_f32_bf16 v7, v105, v17
    v_add_f32_dpp v28, v5, v4 row_ror:8 row_mask:0xf bank_mask:0xf
    v_dot2c_f32_bf16 v6, v106, v10
    v_dot2c_f32_bf16 v7, v106, v18
    v_add_f32_dpp v28, v28, v28 row_half_mirror row_mask:0xf bank_mask:0xf
    v_dot2c_f32_bf16 v6, v107, v11
    v_dot2c_f32_bf16 v7, v107, v19
    v_add_f32_dpp v28, v28, v28 quad_perm:[1,0,3,2] row_mask:0xf bank_mask:0xf
    s_waitcnt vmcnt(38)
    v_dot2c_f32_bf16 v6, v108, v12
    v_dot2c_f32_bf16 v7, v108, v20
    v_add_f32_dpp v28, v28, v28 quad_perm:[2,3,0,1] row_mask:0xf bank_mask:0xf
    v_dot2c_f32_bf16 v6, v109, v13
    v_dot2c_f32_bf16 v7, v109, v21
    v_cvt_pk_bf16_f32 v28, v28, v28
    v_dot2c_f32_bf16 v6, v110, v14
    v_dot2c_f32_bf16 v7, v110, v22
    v_and_b32 v28, 0xffff0000, v28
    v_dot2c_f32_bf16 v6, v111, v15
    v_dot2c_f32_bf16 v7, v111, v23
    s_bitcmp1_b32 s62, 0
    s_cbranch_scc1 L_th50
    s_waitcnt vmcnt(5)
L_th50:
    buffer_load_dwordx4 v[72:75], v1, s[32:35], s6 offen offset:0 nt
    v_mov_b32 v4, 0
    v_mov_b32 v5, 0
    s_waitcnt vmcnt(38)
    v_dot2c_f32_bf16 v4, v112, v8
    v_dot2c_f32_bf16 v5, v112, v16
    v_dot2c_f32_bf16 v4, v113, v9
    v_dot2c_f32_bf16 v5, v113, v17
    v_add_f32_dpp v29, v7, v6 row_ror:8 row_mask:0xf bank_mask:0xf
    v_dot2c_f32_bf16 v4, v114, v10
    v_dot2c_f32_bf16 v5, v114, v18
    v_add_f32_dpp v29, v29, v29 row_half_mirror row_mask:0xf bank_mask:0xf
    v_dot2c_f32_bf16 v4, v115, v11
    v_dot2c_f32_bf16 v5, v115, v19
    v_add_f32_dpp v29, v29, v29 quad_perm:[1,0,3,2] row_mask:0xf bank_mask:0xf
    s_waitcnt vmcnt(37)
    v_dot2c_f32_bf16 v4, v116, v12
    v_dot2c_f32_bf16 v5, v116, v20
    v_add_f32_dpp v29, v29, v29 quad_perm:[2,3,0,1] row_mask:0xf bank_mask:0xf
    v_dot2c_f32_bf16 v4, v117, v13
    v_dot2c_f32_bf16 v5, v117, v21
    v_cvt_pk_bf16_f32 v29, v29, v29
    v_dot2c_f32_bf16 v4, v118, v14
    v_dot2c_f32_bf16 v5, v118, v22
    v_and_b32 v29, 0xffff0000, v29
    v_dot2c_f32_bf16 v4, v119, v15
    v_dot2c_f32_bf16 v5, v119, v23
    v_mov_b32 v6, 0
    v_mov_b32 v7, 0
    s_waitcnt vmcnt(36)
    v_dot2c_f32_bf16 v6, v120, v8
    v_dot2c_f32_bf16 v7, v120, v16
    v_dot2c_f32_bf16 v6, v121, v9
    v_dot2c_f32_bf16 v7, v121, v17
    v_add_f32_dpp v30, v5, v4 row_ror:8 row_mask:0xf bank_mask:0xf
    v_dot2c_f32_bf16 v6, v122, v10
    v_dot2c_f32_bf16 v7, v122, v18
    v_add_f32_dpp v30, v30, v30 row_half_mirror row_mask:0xf bank_mask:0xf
    v_dot2c_f32_bf16 v6, v123, v11
    v_dot2c_f32_bf16 v7, v123, v19
    v_add_f32_dpp v30, v30, v30 quad_perm:[1,0,3,2] row_mask:0xf bank_mask:0xf
    s_waitcnt vmcnt(35)
    v_dot2c_f32_bf16 v6, v124, v12
    v_dot2c_f32_bf16 v7, v124, v20
    v_add_f32_dpp v30, v30, v30 quad_perm:[2,3,0,1] row_mask:0xf bank_mask:0xf
    v_dot2c_f32_bf16 v6, v125, v13
    v_dot2c_f32_bf16 v7, v125, v21
    v_cvt_pk_bf16_f32 v30, v30, v30
    v_dot2c_f32_bf16 v6, v126, v14
    v_dot2c_f32_bf16 v7, v126, v22
    v_and_b32 v30, 0xffff0000, v30
    v_dot2c_f32_bf16 v6, v127, v15
    v_dot2c_f32_bf16 v7, v127, v23
    s_bitcmp1_b32 s62, 1
    s_cbranch_scc1 L_th51
    s_waitcnt vmcnt(5)
L_th51:
    buffer_load_dwordx4 v[76:79], v1, s[32:35], s6 offen offset:256 nt
    s_add_u32 s6, s6, 0x2000
    s_and_b32 s6, s6, 0x3ffff
    v_mov_b32 v4, 0
    v_mov_b32 v5, 0
    s_waitcnt vmcnt(35)
    v_dot2c_f32_bf16 v4, v128, v8
    v_dot2c_f32_bf16 v5, v128, v16
    v_dot2c_f32_bf16 v4, v129, v9
    v_dot2c_f32_bf16 v5, v129, v17
    v_add_f32_dpp v31, v7, v6 row_ror:8 row_mask:0xf bank_mask:0xf
    v_dot2c_f32_bf16 v4, v130, v10
    v_dot2c_f32_bf16 v5, v130, v18
    v_add_f32_dpp v31, v31, v31 row_half_mirror row_mask:0xf bank_mask:0xf
    v_dot2c_f32_bf16 v4, v131, v11
    v_dot2c_f32_bf16 v5, v131, v19
    v_add_f32_dpp v31, v31, v31 quad_perm:[1,0,3,2] row_mask:0xf bank_mask:0xf
    s_waitcnt vmcnt(34)
    v_dot2c_f32_bf16 v4, v132, v12
    v_dot2c_f32_bf16 v5, v132, v20
    v_add_f32_dpp v31, v31, v31 quad_perm:[2,3,0,1] row_mask:0xf bank_mask:0xf
    v_dot2c_f32_bf16 v4, v133, v13
    v_dot2c_f32_bf16 v5, v133, v21
    v_cvt_pk_bf16_f32 v31, v31, v31
    v_dot2c_f32_bf16 v4, v134, v14
    v_dot2c_f32_bf16 v5, v134, v22
    v_and_b32 v31, 0xffff0000, v31
    v_dot2c_f32_bf16 v4, v135, v15
    v_dot2c_f32_bf16 v5, v135, v23
    v_mov_b32 v6, 0
    v_mov_b32 v7, 0
    s_waitcnt vmcnt(33)
    v_dot2c_f32_bf16 v6, v136, v8
    v_dot2c_f32_bf16 v7, v136, v16
    v_dot2c_f32_bf16 v6, v137, v9
    v_dot2c_f32_bf16 v7, v137, v17
    v_add_f32_dpp v32, v5, v4 row_ror:8 row_mask:0xf bank_mask:0xf
    v_dot2c_f32_bf16 v6, v138, v10
    v_dot2c_f32_bf16 v7, v138, v18
    v_add_f32_dpp v32, v32, v32 row_half_mirror row_mask:0xf bank_mask:0xf
    v_dot2c_f32_bf16 v6, v139, v11
    v_dot2c_f32_bf16 v7, v139, v19
    v_add_f32_dpp v32, v32, v32 quad_perm:[1,0,3,2] row_mask:0xf bank_mask:0xf
    s_waitcnt vmcnt(32)
    v_dot2c_f32_bf16 v6, v140, v12
    v_dot2c_f32_bf16 v7, v140, v20
    v_add_f32_dpp v32, v32, v32 quad_perm:[2,3,0,1] row_mask:0xf bank_mask:0xf
    v_dot2c_f32_bf16 v6, v141, v13
    v_dot2c_f32_bf16 v7, v141, v21
    v_cvt_pk_bf16_f32 v32, v32, v32
    v_dot2c_f32_bf16 v6, v142, v14
    v_dot2c_f32_bf16 v7, v142, v22
    v_and_b32 v32, 0xffff0000, v32
    v_dot2c_f32_bf16 v6, v143, v15
    v_dot2c_f32_bf16 v7, v143, v23
    s_bitcmp1_b32 s62, 0
    s_cbranch_scc1 L_th52
    s_waitcnt vmcnt(5)
L_th52:
    buffer_load_dwordx4 v[80:83], v1, s[32:35], s6 offen offset:0 nt
    v_mov_b32 v4, 0
    v_mov_b32 v5, 0
    s_waitcnt vmcnt(32)
    v_dot2c_f32_bf16 v4, v144, v8
    v_dot2c_f32_bf16 v5, v144, v16
    v_dot2c_f32_bf16 v4, v145, v9
    v_dot2c_f32_bf16 v5, v145, v17
    v_add_f32_dpp v33, v7, v6 row_ror:8 row_mask:0xf bank_mask:0xf
    v_dot2c_f32_bf16 v4, v146, v10
    v_dot2c_f32_bf16 v5, v146, v18
    v_add_f32_dpp v33, v33, v33 row_half_mirror row_mask:0xf bank_mask:0xf
    v_dot2c_f32_bf16 v4, v147, v11
    v_dot2c_f32_bf16 v5, v147, v19
    v_add_f32_dpp v33, v33, v33 quad_perm:[1,0,3,2] row_mask:0xf bank_mask:0xf
    s_waitcnt vmcnt(31)
    v_dot2c_f32_bf16 v4, v148, v12
    v_dot2c_f32_bf16 v5, v148, v20
    v_add_f32_dpp v33, v33, v33 quad_perm:[2,3,0,1] row_mask:0xf bank_mask:0xf
    v_dot2c_f32_bf16 v4, v149, v13
    v_dot2c_f32_bf16 v5, v149, v21
    v_cvt_pk_bf16_f32 v33, v33, v33
    v_dot2c_f32_bf16 v4, v150, v14
    v_dot2c_f32_bf16 v5, v150, v22
    v_and_b32 v33, 0xffff0000, v33
    v_dot2c_f32_bf16 v4, v151, v15
    v_dot2c_f32_bf16 v5, v151, v23
    v_mov_b32 v6, 0
    v_mov_b32 v7, 0
    s_waitcnt vmcnt(30)
    v_dot2c_f32_bf16 v6, v152, v8
    v_dot2c_f32_bf16 v7, v152, v16
    v_dot2c_f32_bf16 v6, v153, v9
    v_dot2c_f32_bf16 v7, v153, v17
    v_add_f32_dpp v34, v5, v4 row_ror:8 row_mask:0xf bank_mask:0xf
    v_dot2c_f32_bf16 v6, v154, v10
    v_dot2c_f32_bf16 v7, v154, v18
    v_add_f32_dpp v34, v34, v34 row_half_mirror row_mask:0xf bank_mask:0xf
    v_dot2c_f32_bf16 v6, v155, v11
    v_dot2c_f32_bf16 v7, v155, v19
    v_add_f32_dpp v34, v34, v34 quad_perm:[1,0,3,2] row_mask:0xf bank_mask:0xf
    s_waitcnt vmcnt(29)
    v_dot2c_f32_bf16 v6, v156, v12
    v_dot2c_f32_bf16 v7, v156, v20
    v_add_f32_dpp v34, v34, v34 quad_perm:[2,3,0,1] row_mask:0xf bank_mask:0xf
    v_dot2c_f32_bf16 v6, v157, v13
    v_dot2c_f32_bf16 v7, v157, v21
    v_cvt_pk_bf16_f32 v34, v34, v34
    v_dot2c_f32_bf16 v6, v158, v14
    v_dot2c_f32_bf16 v7, v158, v22
    v_and_b32 v34, 0xffff0000, v34
    v_dot2c_f32_bf16 v6, v159, v15
    v_dot2c_f32_bf16 v7, v159, v23
    s_bitcmp1_b32 s62, 1
    s_cbranch_scc1 L_th53
    s_waitcnt vmcnt(5)
L_th53:
    buffer_load_dwordx4 v[84:87], v1, s[32:35], s6 offen offset:256 nt
    s_add_u32 s6, s6, 0x2000
    s_and_b32 s6, s6, 0x3ffff
    v_mov_b32 v4, 0
    v_mov_b32 v5, 0
    s_waitcnt vmcnt(29)
    v_dot2c_f32_bf16 v4, v160, v8
    v_dot2c_f32_bf16 v5, v160, v16
    v_dot2c_f32_bf16 v4, v161, v9
    v_dot2c_f32_bf16 v5, v161, v17
    v_add_f32_dpp v35, v7, v6 row_ror:8 row_mask:0xf bank_mask:0xf
    v_dot2c_f32_bf16 v4, v162, v10
    v_dot2c_f32_bf16 v5, v162, v18
    v_add_f32_dpp v35, v35, v35 row_half_mirror row_mask:0xf bank_mask:0xf
    v_dot2c_f32_bf16 v4, v163, v11
    v_dot2c_f32_bf16 v5, v163, v19
    v_add_f32_dpp v35, v35, v35 quad_perm:[1,0,3,2] row_mask:0xf bank_mask:0xf
    s_waitcnt vmcnt(28)
    v_dot2c_f32_bf16 v4, v164, v12
    v_dot2c_f32_bf16 v5, v164, v20
    v_add_f32_dpp v35, v35, v35 quad_perm:[2,3,0,1] row_mask:0xf bank_mask:0xf
    v_dot2c_f32_bf16 v4, v165, v13
    v_dot2c_f32_bf16 v5, v165, v21
    v_cvt_pk_bf16_f32 v35, v35, v35
    v_dot2c_f32_bf16 v4, v166, v14
    v_dot2c_f32_bf16 v5, v166, v22
    v_and_b32 v35, 0xffff0000, v35
    v_dot2c_f32_bf16 v4, v167, v15
    v_dot2c_f32_bf16 v5, v167, v23
    v_mov_b32 v6, 0
    v_mov_b32 v7, 0
    s_waitcnt vmcnt(27)
    v_dot2c_f32_bf16 v6, v168, v8
    v_dot2c_f32_bf16 v7, v168, v16
    v_dot2c_f32_bf16 v6, v169, v9
    v_dot2c_f32_bf16 v7, v169, v17
    v_add_f32_dpp v36, v5, v4 row_ror:8 row_mask:0xf bank_mask:0xf
    v_dot2c_f32_bf16 v6, v170, v10
    v_dot2c_f32_bf16 v7, v170, v18
    v_add_f32_dpp v36, v36, v36 row_half_mirror row_mask:0xf bank_mask:0xf
    v_dot2c_f32_bf16 v6, v171, v11
    v_dot2c_f32_bf16 v7, v171, v19
    v_add_f32_dpp v36, v36, v36 quad_perm:[1,0,3,2] row_mask:0xf bank_mask:0xf
    s_waitcnt vmcnt(26)
    v_dot2c_f32_bf16 v6, v172, v12
    v_dot2c_f32_bf16 v7, v172, v20
    v_add_f32_dpp v36, v36, v36 quad_perm:[2,3,0,1] row_mask:0xf bank_mask:0xf
    v_dot2c_f32_bf16 v6, v173, v13
    v_dot2c_f32_bf16 v7, v173, v21
    v_cvt_pk_bf16_f32 v36, v36, v36
    v_dot2c_f32_bf16 v6, v174, v14
    v_dot2c_f32_bf16 v7, v174, v22
    v_and_b32 v36, 0xffff0000, v36
    v_dot2c_f32_bf16 v6, v175, v15
    v_dot2c_f32_bf16 v7, v175, v23
    s_bitcmp1_b32 s62, 0
    s_cbranch_scc1 L_th54
    s_waitcnt vmcnt(5)
L_th54:
    buffer_load_dwordx4 v[88:91], v1, s[32:35], s6 offen offset:0 nt
    v_mov_b32 v4, 0
    v_mov_b32 v5, 0
    s_waitcnt vmcnt(26)
    v_dot2c_f32_bf16 v4, v176, v8
    v_dot2c_f32_bf16 v5, v176, v16
    v_dot2c_f32_bf16 v4, v177, v9
    v_dot2c_f32_bf16 v5, v177, v17
    v_add_f32_dpp v37, v7, v6 row_ror:8 row_mask:0xf bank_mask:0xf
    v_dot2c_f32_bf16 v4, v178, v10
    v_dot2c_f32_bf16 v5, v178, v18
    v_add_f32_dpp v37, v37, v37 row_half_mirror row_mask:0xf bank_mask:0xf
    v_dot2c_f32_bf16 v4, v179, v11
    v_dot2c_f32_bf16 v5, v179, v19
    v_add_f32_dpp v37, v37, v37 quad_perm:[1,0,3,2] row_mask:0xf bank_mask:0xf
    s_waitcnt vmcnt(25)
    v_dot2c_f32_bf16 v4, v180, v12
    v_dot2c_f32_bf16 v5, v180, v20
    v_add_f32_dpp v37, v37, v37 quad_perm:[2,3,0,1] row_mask:0xf bank_mask:0xf
    v_dot2c_f32_bf16 v4, v181, v13
    v_dot2c_f32_bf16 v5, v181, v21
    v_cvt_pk_bf16_f32 v37, v37, v37
    v_dot2c_f32_bf16 v4, v182, v14
    v_dot2c_f32_bf16 v5, v182, v22
    v_and_b32 v37, 0xffff0000, v37
    v_dot2c_f32_bf16 v4, v183, v15
    v_dot2c_f32_bf16 v5, v183, v23
    v_mov_b32 v6, 0
    v_mov_b32 v7, 0
    s_waitcnt vmcnt(24)
    v_dot2c_f32_bf16 v6, v184, v8
    v_dot2c_f32_bf16 v7, v184, v16
    v_dot2c_f32_bf16 v6, v185, v9
    v_dot2c_f32_bf16 v7, v185, v17
    v_add_f32_dpp v38, v5, v4 row_ror:8 row_mask:0xf bank_mask:0xf
    v_dot2c_f32_bf16 v6, v186, v10
    v_dot2c_f32_bf16 v7, v186, v18
    v_add_f32_dpp v38, v38, v38 row_half_mirror row_mask:0xf bank_mask:0xf
    v_dot2c_f32_bf16 v6, v187, v11
    v_dot2c_f32_bf16 v7, v187, v19
    v_add_f32_dpp v38, v38, v38 quad_perm:[1,0,3,2] row_mask:0xf bank_mask:0xf
    s_waitcnt vmcnt(23)
    v_dot2c_f32_bf16 v6, v188, v12
    v_dot2c_f32_bf16 v7, v188, v20
    v_add_f32_dpp v38, v38, v38 quad_perm:[2,3,0,1] row_mask:0xf bank_mask:0xf
    v_dot2c_f32_bf16 v6, v189, v13
    v_dot2c_f32_bf16 v7, v189, v21
    v_cvt_pk_bf16_f32 v38, v38, v38
    v_dot2c_f32_bf16 v6, v190, v14
    v_dot2c_f32_bf16 v7, v190, v22
    v_and_b32 v38, 0xffff0000, v38
    v_dot2c_f32_bf16 v6, v191, v15
    v_dot2c_f32_bf16 v7, v191, v23
    s_bitcmp1_b32 s62, 1
    s_cbranch_scc1 L_th55
    s_waitcnt vmcnt(5)
L_th55:
    buffer_load_dwordx4 v[92:95], v1, s[32:35], s6 offen offset:256 nt
    s_add_u32 s6, s6, 0x2000
    s_and_b32 s6, s6, 0x3ffff
    v_mov_b32 v4, 0
    v_mov_b32 v5, 0
    s_waitcnt vmcnt(23)
    v_dot2c_f32_bf16 v4, v192, v8
    v_dot2c_f32_bf16 v5, v192, v16
    v_dot2c_f32_bf16 v4, v193, v9
    v_dot2c_f32_bf16 v5, v193, v17
    v_add_f32_dpp v39, v7, v6 row_ror:8 row_mask:0xf bank_mask:0xf
    v_dot2c_f32_bf16 v4, v194, v10
    v_dot2c_f32_bf16 v5, v194, v18
    v_add_f32_dpp v39, v39, v39 row_half_mirror row_mask:0xf bank_mask:0xf
    v_dot2c_f32_bf16 v4, v195, v11
    v_dot2c_f32_bf16 v5, v195, v19
    v_add_f32_dpp v39, v39, v39 quad_perm:[1,0,3,2] row_mask:0xf bank_mask:0xf
    s_waitcnt vmcnt(22)
    v_dot2c_f32_bf16 v4, v196, v12
    v_dot2c_f32_bf16 v5, v196, v20
    v_add_f32_dpp v39, v39, v39 quad_perm:[2,3,0,1] row_mask:0xf bank_mask:0xf
    v_dot2c_f32_bf16 v4, v197, v13
    v_dot2c_f32_bf16 v5, v197, v21
    v_cvt_pk_bf16_f32 v39, v39, v39
    v_dot2c_f32_bf16 v4, v198, v14
    v_dot2c_f32_bf16 v5, v198, v22
    v_and_b32 v39, 0xffff0000, v39
    v_dot2c_f32_bf16 v4, v199, v15
    v_dot2c_f32_bf16 v5, v199, v23
    v_mov_b32 v6, 0
    v_mov_b32 v7, 0
    s_waitcnt vmcnt(21)
    v_dot2c_f32_bf16 v6, v200, v8
    v_dot2c_f32_bf16 v7, v200, v16
    v_dot2c_f32_bf16 v6, v201, v9
    v_dot2c_f32_bf16 v7, v201, v17
    v_add_f32_dpp v40, v5, v4 row_ror:8 row_mask:0xf bank_mask:0xf
    v_dot2c_f32_bf16 v6, v202, v10
    v_dot2c_f32_bf16 v7, v202, v18
    v_add_f32_dpp v40, v40, v40 row_half_mirror row_mask:0xf bank_mask:0xf
    v_dot2c_f32_bf16 v6, v203, v11
    v_dot2c_f32_bf16 v7, v203, v19
    v_add_f32_dpp v40, v40, v40 quad_perm:[1,0,3,2] row_mask:0xf bank_mask:0xf
    s_waitcnt vmcnt(20)
    v_dot2c_f32_bf16 v6, v204, v12
    v_dot2c_f32_bf16 v7, v204, v20
    v_add_f32_dpp v40, v40, v40 quad_perm:[2,3,0,1] row_mask:0xf bank_mask:0xf
    v_dot2c_f32_bf16 v6, v205, v13
    v_dot2c_f32_bf16 v7, v205, v21
    v_cvt_pk_bf16_f32 v40, v40, v40
    v_dot2c_f32_bf16 v6, v206, v14
    v_dot2c_f32_bf16 v7, v206, v22
    v_and_b32 v40, 0xffff0000, v40
    v_dot2c_f32_bf16 v6, v207, v15
    v_dot2c_f32_bf16 v7, v207, v23
    s_bitcmp1_b32 s62, 0
    s_cbranch_scc1 L_th56
    s_waitcnt vmcnt(5)
L_th56:
    buffer_load_dwordx4 v[96:99], v1, s[32:35], s6 offen offset:0 nt
    v_mov_b32 v4, 0
    v_mov_b32 v5, 0
    s_waitcnt vmcnt(20)
    v_dot2c_f32_bf16 v4, v208, v8
    v_dot2c_f32_bf16 v5, v208, v16
    v_dot2c_f32_bf16 v4, v209, v9
    v_dot2c_f32_bf16 v5, v209, v17
    v_add_f32_dpp v41, v7, v6 row_ror:8 row_mask:0xf bank_mask:0xf
    v_dot2c_f32_bf16 v4, v210, v10
    v_dot2c_f32_bf16 v5, v210, v18
    v_add_f32_dpp v41, v41, v41 row_half_mirror row_mask:0xf bank_mask:0xf
    v_dot2c_f32_bf16 v4, v211, v11
    v_dot2c_f32_bf16 v5, v211, v19
    v_add_f32_dpp v41, v41, v41 quad_perm:[1,0,3,2] row_mask:0xf bank_mask:0xf
    s_waitcnt vmcnt(19)
    v_dot2c_f32_bf16 v4, v212, v12
    v_dot2c_f32_bf16 v5, v212, v20
    v_add_f32_dpp v41, v41, v41 quad_perm:[2,3,0,1] row_mask:0xf bank_mask:0xf
    v_dot2c_f32_bf16 v4, v213, v13
    v_dot2c_f32_bf16 v5, v213, v21
    v_cvt_pk_bf16_f32 v41, v41, v41
    v_dot2c_f32_bf16 v4, v214, v14
    v_dot2c_f32_bf16 v5, v214, v22
    v_and_b32 v41, 0xffff0000, v41
    v_dot2c_f32_bf16 v4, v215, v15
    v_dot2c_f32_bf16 v5, v215, v23
    v_mov_b32 v6, 0
    v_mov_b32 v7, 0
    s_waitcnt vmcnt(18)
    v_dot2c_f32_bf16 v6, v216, v8
    v_dot2c_f32_bf16 v7, v216, v16
    v_dot2c_f32_bf16 v6, v217, v9
    v_dot2c_f32_bf16 v7, v217, v17
    v_add_f32_dpp v42, v5, v4 row_ror:8 row_mask:0xf bank_mask:0xf
    v_dot2c_f32_bf16 v6, v218, v10
    v_dot2c_f32_bf16 v7, v218, v18
    v_add_f32_dpp v42, v42, v42 row_half_mirror row_mask:0xf bank_mask:0xf
    v_dot2c_f32_bf16 v6, v219, v11
    v_dot2c_f32_bf16 v7, v219, v19
    v_add_f32_dpp v42, v42, v42 quad_perm:[1,0,3,2] row_mask:0xf bank_mask:0xf
    s_waitcnt vmcnt(17)
    v_dot2c_f32_bf16 v6, v220, v12
    v_dot2c_f32_bf16 v7, v220, v20
    v_add_f32_dpp v42, v42, v42 quad_perm:[2,3,0,1] row_mask:0xf bank_mask:0xf
    v_dot2c_f32_bf16 v6, v221, v13
    v_dot2c_f32_bf16 v7, v221, v21
    v_cvt_pk_bf16_f32 v42, v42, v42
    v_dot2c_f32_bf16 v6, v222, v14
    v_dot2c_f32_bf16 v7, v222, v22
    v_and_b32 v42, 0xffff0000, v42
    v_dot2c_f32_bf16 v6, v223, v15
    v_dot2c_f32_bf16 v7, v223, v23
    s_bitcmp1_b32 s62, 1
    s_cbranch_scc1 L_th57
    s_waitcnt vmcnt(5)
L_th57:
    buffer_load_dwordx4 v[100:103], v1, s[32:35], s6 offen offset:256 nt
    s_add_u32 s6, s6, 0x2000
    s_and_b32 s6, s6, 0x3ffff
    v_mov_b32 v4, 0
    v_mov_b32 v5, 0
    s_waitcnt vmcnt(17)
    v_dot2c_f32_bf16 v4, v224, v8
    v_dot2c_f32_bf16 v5, v224, v16
    v_dot2c_f32_bf16 v4, v225, v9
    v_dot2c_f32_bf16 v5, v225, v17
    v_add_f32_dpp v43, v7, v6 row_ror:8 row_mask:0xf bank_mask:0xf
    v_dot2c_f32_bf16 v4, v226, v10
    v_dot2c_f32_bf16 v5, v226, v18
    v_add_f32_dpp v43, v43, v43 row_half_mirror row_mask:0xf bank_mask:0xf
    v_dot2c_f32_bf16 v4, v227, v11
    v_dot2c_f32_bf16 v5, v227, v19
    v_add_f32_dpp v43, v43, v43 quad_perm:[1,0,3,2] row_mask:0xf bank_mask:0xf
    s_waitcnt vmcnt(16)
    v_dot2c_f32_bf16 v4, v228, v12
    v_dot2c_f32_bf16 v5, v228, v20
    v_add_f32_dpp v43, v43, v43 quad_perm:[2,3,0,1] row_mask:0xf bank_mask:0xf
    v_dot2c_f32_bf16 v4, v229, v13
    v_dot2c_f32_bf16 v5, v229, v21
    v_cvt_pk_bf16_f32 v43, v43, v43
    v_dot2c_f32_bf16 v4, v230, v14
    v_dot2c_f32_bf16 v5, v230, v22
    v_and_b32 v43, 0xffff0000, v43
    v_dot2c_f32_bf16 v4, v231, v15
    v_dot2c_f32_bf16 v5, v231, v23
    v_mov_b32 v6, 0
    v_mov_b32 v7, 0
    s_waitcnt vmcnt(15)
    v_dot2c_f32_bf16 v6, v232, v8
    v_dot2c_f32_bf16 v7, v232, v16
    v_dot2c_f32_bf16 v6, v233, v9
    v_dot2c_f32_bf16 v7, v233, v17
    v_add_f32_dpp v44, v5, v4 row_ror:8 row_mask:0xf bank_mask:0xf
    v_dot2c_f32_bf16 v6, v234, v10
    v_dot2c_f32_bf16 v7, v234, v18
    v_add_f32_dpp v44, v44, v44 row_half_mirror row_mask:0xf bank_mask:0xf
    v_dot2c_f32_bf16 v6, v235, v11
    v_dot2c_f32_bf16 v7, v235, v19
    v_add_f32_dpp v44, v44, v44 quad_perm:[1,0,3,2] row_mask:0xf bank_mask:0xf
    s_waitcnt vmcnt(14)
    v_dot2c_f32_bf16 v6, v236, v12
    v_dot2c_f32_bf16 v7, v236, v20
    v_add_f32_dpp v44, v44, v44 quad_perm:[2,3,0,1] row_mask:0xf bank_mask:0xf
    v_dot2c_f32_bf16 v6, v237, v13
    v_dot2c_f32_bf16 v7, v237, v21
    v_cvt_pk_bf16_f32 v44, v44, v44
    v_dot2c_f32_bf16 v6, v238, v14
    v_dot2c_f32_bf16 v7, v238, v22
    v_and_b32 v44, 0xffff0000, v44
    v_dot2c_f32_bf16 v6, v239, v15
    v_dot2c_f32_bf16 v7, v239, v23
    s_bitcmp1_b32 s62, 0
    s_cbranch_scc1 L_th58
    s_waitcnt vmcnt(5)
L_th58:
    buffer_load_dwordx4 v[104:107], v1, s[32:35], s6 offen offset:0 nt
    v_mov_b32 v4, 0
    v_mov_b32 v5, 0
    s_waitcnt vmcnt(14)
    v_dot2c_f32_bf16 v4, v240, v8
    v_dot2c_f32_bf16 v5, v240, v16
    v_dot2c_f32_bf16 v4, v241, v9
    v_dot2c_f32_bf16 v5, v241, v17
    v_add_f32_dpp v45, v7, v6 row_ror:8 row_mask:0xf bank_mask:0xf
    v_dot2c_f32_bf16 v4, v242, v10
    v_dot2c_f32_bf16 v5, v242, v18
    v_add_f32_dpp v45, v45, v45 row_half_mirror row_mask:0xf bank_mask:0xf
    v_dot2c_f32_bf16 v4, v243, v11
    v_dot2c_f32_bf16 v5, v243, v19
    v_add_f32_dpp v45, v45, v45 quad_perm:[1,0,3,2] row_mask:0xf bank_mask:0xf
    s_waitcnt vmcnt(13)
    v_dot2c_f32_bf16 v4, v244, v12
    v_dot2c_f32_bf16 v5, v244, v20
    v_add_f32_dpp v45, v45, v45 quad_perm:[2,3,0,1] row_mask:0xf bank_mask:0xf
    v_dot2c_f32_bf16 v4, v245, v13
    v_dot2c_f32_bf16 v5, v245, v21
    v_cvt_pk_bf16_f32 v45, v45, v45
    v_dot2c_f32_bf16 v4, v246, v14
    v_dot2c_f32_bf16 v5, v246, v22
    v_and_b32 v45, 0xffff0000, v45
    v_dot2c_f32_bf16 v4, v247, v15
    v_dot2c_f32_bf16 v5, v247, v23
    v_mov_b32 v6, 0
    v_mov_b32 v7, 0
    s_waitcnt vmcnt(12)
    v_dot2c_f32_bf16 v6, v248, v8
    v_dot2c_f32_bf16 v7, v248, v16
    v_dot2c_f32_bf16 v6, v249, v9
    v_dot2c_f32_bf16 v7, v249, v17
    v_add_f32_dpp v46, v5, v4 row_ror:8 row_mask:0xf bank_mask:0xf
    v_dot2c_f32_bf16 v6, v250, v10
    v_dot2c_f32_bf16 v7, v250, v18
    v_add_f32_dpp v46, v46, v46 row_half_mirror row_mask:0xf bank_mask:0xf
    v_dot2c_f32_bf16 v6, v251, v11
    v_dot2c_f32_bf16 v7, v251, v19
    v_add_f32_dpp v46, v46, v46 quad_perm:[1,0,3,2] row_mask:0xf bank_mask:0xf
    s_waitcnt vmcnt(11)
    v_dot2c_f32_bf16 v6, v252, v12
    v_dot2c_f32_bf16 v7, v252, v20
    v_add_f32_dpp v46, v46, v46 quad_perm:[2,3,0,1] row_mask:0xf bank_mask:0xf
    v_dot2c_f32_bf16 v6, v253, v13
    v_dot2c_f32_bf16 v7, v253, v21
    v_cvt_pk_bf16_f32 v46, v46, v46
    v_dot2c_f32_bf16 v6, v254, v14
    v_dot2c_f32_bf16 v7, v254, v22
    v_and_b32 v46, 0xffff0000, v46
    v_dot2c_f32_bf16 v6, v255, v15
    v_dot2c_f32_bf16 v7, v255, v23
    s_bitcmp1_b32 s62, 1
    s_cbranch_scc1 L_th59
    s_waitcnt vmcnt(5)
L_th59:
    buffer_load_dwordx4 v[108:111], v1, s[32:35], s6 offen offset:256 nt
    s_add_u32 s6, s6, 0x2000
    s_and_b32 s6, s6, 0x3ffff
    v_mov_b32 v4, 0
    v_mov_b32 v5, 0
    s_waitcnt vmcnt(11)
    v_dot2c_f32_bf16 v4, v64, v8
    v_dot2c_f32_bf16 v5, v64, v16
    v_dot2c_f32_bf16 v4, v65, v9
    v_dot2c_f32_bf16 v5, v65, v17
    v_add_f32_dpp v47, v7, v6 row_ror:8 row_mask:0xf bank_mask:0xf
    v_dot2c_f32_bf16 v4, v66, v10
    v_dot2c_f32_bf16 v5, v66, v18
    v_add_f32_dpp v47, v47, v47 row_half_mirror row_mask:0xf bank_mask:0xf
    v_dot2c_f32_bf16 v4, v67, v11
    v_dot2c_f32_bf16 v5, v67, v19
    v_add_f32_dpp v47, v47, v47 quad_perm:[1,0,3,2] row_mask:0xf bank_mask:0xf
    s_waitcnt vmcnt(10)
    v_dot2c_f32_bf16 v4, v68, v12
    v_dot2c_f32_bf16 v5, v68, v20
    v_add_f32_dpp v47, v47, v47 quad_perm:[2,3,0,1] row_mask:0xf bank_mask:0xf
    v_dot2c_f32_bf16 v4, v69, v13
    v_dot2c_f32_bf16 v5, v69, v21
    v_cvt_pk_bf16_f32 v47, v47, v47
    v_dot2c_f32_bf16 v4, v70, v14
    v_dot2c_f32_bf16 v5, v70, v22
    v_and_b32 v47, 0xffff0000, v47
    v_dot2c_f32_bf16 v4, v71, v15
    v_dot2c_f32_bf16 v5, v71, v23
    v_mov_b32 v6, 0
    v_mov_b32 v7, 0
    s_waitcnt vmcnt(9)
    v_dot2c_f32_bf16 v6, v72, v8
    v_dot2c_f32_bf16 v7, v72, v16
    v_dot2c_f32_bf16 v6, v73, v9
    v_dot2c_f32_bf16 v7, v73, v17
    v_add_f32_dpp v48, v5, v4 row_ror:8 row_mask:0xf bank_mask:0xf
    v_dot2c_f32_bf16 v6, v74, v10
    v_dot2c_f32_bf16 v7, v74, v18
    v_add_f32_dpp v48, v48, v48 row_half_mirror row_mask:0xf bank_mask:0xf
    v_dot2c_f32_bf16 v6, v75, v11
    v_dot2c_f32_bf16 v7, v75, v19
    v_add_f32_dpp v48, v48, v48 quad_perm:[1,0,3,2] row_mask:0xf bank_mask:0xf
    s_waitcnt vmcnt(8)
    v_dot2c_f32_bf16 v6, v76, v12
    v_dot2c_f32_bf16 v7, v76, v20
    v_add_f32_dpp v48, v48, v48 quad_perm:[2,3,0,1] row_mask:0xf bank_mask:0xf
    v_dot2c_f32_bf16 v6, v77, v13
    v_dot2c_f32_bf16 v7, v77, v21
    v_cvt_pk_bf16_f32 v48, v48, v48
    v_dot2c_f32_bf16 v6, v78, v14
    v_dot2c_f32_bf16 v7, v78, v22
    v_and_b32 v48, 0xffff0000, v48
    v_dot2c_f32_bf16 v6, v79, v15
    v_dot2c_f32_bf16 v7, v79, v23
    s_bitcmp1_b32 s62, 0
    s_cbranch_scc1 L_th60
    s_waitcnt vmcnt(5)
L_th60:
    buffer_load_dwordx4 v[112:115], v1, s[32:35], s6 offen offset:0 nt
    v_mov_b32 v4, 0
    v_mov_b32 v5, 0
    s_waitcnt vmcnt(8)
    v_dot2c_f32_bf16 v4, v80, v8
    v_dot2c_f32_bf16 v5, v80, v16
    v_dot2c_f32_bf16 v4, v81, v9
    v_dot2c_f32_bf16 v5, v81, v17
    v_add_f32_dpp v49, v7, v6 row_ror:8 row_mask:0xf bank_mask:0xf
    v_dot2c_f32_bf16 v4, v82, v10
    v_dot2c_f32_bf16 v5, v82, v18
    v_add_f32_dpp v49, v49, v49 row_half_mirror row_mask:0xf bank_mask:0xf
    v_dot2c_f32_bf16 v4, v83, v11
    v_dot2c_f32_bf16 v5, v83, v19
    v_add_f32_dpp v49, v49, v49 quad_perm:[1,0,3,2] row_mask:0xf bank_mask:0xf
    s_waitcnt vmcnt(7)
    v_dot2c_f32_bf16 v4, v84, v12
    v_dot2c_f32_bf16 v5, v84, v20
    v_add_f32_dpp v49, v49, v49 quad_perm:[2,3,0,1] row_mask:0xf bank_mask:0xf
    v_dot2c_f32_bf16 v4, v85, v13
    v_dot2c_f32_bf16 v5, v85, v21
    v_cvt_pk_bf16_f32 v49, v49, v49
    v_dot2c_f32_bf16 v4, v86, v14
    v_dot2c_f32_bf16 v5, v86, v22
    v_and_b32 v49, 0xffff0000, v49
    v_dot2c_f32_bf16 v4, v87, v15
    v_dot2c_f32_bf16 v5, v87, v23
    s_bitcmp1_b32 s62, 1
    s_cbranch_scc1 L_th61
    s_waitcnt vmcnt(5)
L_th61:
    buffer_load_dwordx4 v[116:119], v1, s[32:35], s6 offen offset:256 nt
    s_add_u32 s6, s6, 0x2000
    s_and_b32 s6, s6, 0x3ffff
    v_mov_b32 v6, 0
    v_mov_b32 v7, 0
    s_waitcnt vmcnt(7)
    v_dot2c_f32_bf16 v6, v88, v8
    v_dot2c_f32_bf16 v7, v88, v16
    v_dot2c_f32_bf16 v6, v89, v9
    v_dot2c_f32_bf16 v7, v89, v17
    v_add_f32_dpp v50, v5, v4 row_ror:8 row_mask:0xf bank_mask:0xf
    v_dot2c_f32_bf16 v6, v90, v10
    v_dot2c_f32_bf16 v7, v90, v18
    v_add_f32_dpp v50, v50, v50 row_half_mirror row_mask:0xf bank_mask:0xf
    v_dot2c_f32_bf16 v6, v91, v11
    v_dot2c_f32_bf16 v7, v91, v19
    v_add_f32_dpp v50, v50, v50 quad_perm:[1,0,3,2] row_mask:0xf bank_mask:0xf
    s_bitcmp1_b32 s62, 0
    s_cbranch_scc1 L_th62
    s_waitcnt vmcnt(5)
L_th62:
    buffer_load_dwordx4 v[120:123], v1, s[32:35], s6 offen offset:0 nt
    s_waitcnt vmcnt(7)
    v_dot2c_f32_bf16 v6, v92, v12
    v_dot2c_f32_bf16 v7, v92, v20
    v_add_f32_dpp v50, v50, v50 quad_perm:[2,3,0,1] row_mask:0xf bank_mask:0xf
    v_dot2c_f32_bf16 v6, v93, v13
    v_dot2c_f32_bf16 v7, v93, v21
    v_cvt_pk_bf16_f32 v50, v50, v50
    v_dot2c_f32_bf16 v6, v94, v14
    v_dot2c_f32_bf16 v7, v94, v22
    v_and_b32 v50, 0xffff0000, v50
    v_dot2c_f32_bf16 v6, v95, v15
    v_dot2c_f32_bf16 v7, v95, v23
    s_bitcmp1_b32 s62, 1
    s_cbranch_scc1 L_th63
    s_waitcnt vmcnt(5)
L_th63:
    buffer_load_dwordx4 v[124:127], v1, s[32:35], s6 offen offset:256 nt
    s_add_u32 s6, s6, 0x2000
    s_and_b32 s6, s6, 0x3ffff
    v_mov_b32 v4, 0
    v_mov_b32 v5, 0
    s_waitcnt vmcnt(7)
    v_dot2c_f32_bf16 v4, v96, v8
    v_dot2c_f32_bf16 v5, v96, v16
    v_dot2c_f32_bf16 v4, v97, v9
    v_dot2c_f32_bf16 v5, v97, v17
    v_add_f32_dpp v51, v7, v6 row_ror:8 row_mask:0xf bank_mask:0xf
    v_dot2c_f32_bf16 v4, v98, v10
    v_dot2c_f32_bf16 v5, v98, v18
    v_add_f32_dpp v51, v51, v51 row_half_mirror row_mask:0xf bank_mask:0xf
    v_dot2c_f32_bf16 v4, v99, v11
    v_dot2c_f32_bf16 v5, v99, v19
    v_add_f32_dpp v51, v51, v51 quad_perm:[1,0,3,2] row_mask:0xf bank_mask:0xf
    s_bitcmp1_b32 s62, 0
    s_cbranch_scc1 L_th64
    s_waitcnt vmcnt(5)
L_th64:
    buffer_load_dwordx4 v[128:131], v1, s[36:39], s6 offen offset:0 nt
    s_waitcnt vmcnt(7)
    v_dot2c_f32_bf16 v4, v100, v12
    v_dot2c_f32_bf16 v5, v100, v20
    v_add_f32_dpp v51, v51, v51 quad_perm:[2,3,0,1] row_mask:0xf bank_mask:0xf
    v_dot2c_f32_bf16 v4, v101, v13
    v_dot2c_f32_bf16 v5, v101, v21
    v_cvt_pk_bf16_f32 v51, v51, v51
    v_dot2c_f32_bf16 v4, v102, v14
    v_dot2c_f32_bf16 v5, v102, v22
    v_and_b32 v51, 0xffff0000, v51
    v_dot2c_f32_bf16 v4, v103, v15
    v_dot2c_f32_bf16 v5, v103, v23
    s_bitcmp1_b32 s62, 1
    s_cbranch_scc1 L_th65
    s_waitcnt vmcnt(5)
L_th65:
    buffer_load_dwordx4 v[132:135], v1, s[36:39], s6 offen offset:256 nt
    s_add_u32 s6, s6, 0x2000
    s_and_b32 s6, s6, 0x3ffff
    v_mov_b32 v6, 0
    v_mov_b32 v7, 0
    s_waitcnt vmcnt(7)
    v_dot2c_f32_bf16 v6, v104, v8
    v_dot2c_f32_bf16 v7, v104, v16
    v_dot2c_f32_bf16 v6, v105, v9
    v_dot2c_f32_bf16 v7, v105, v17
    v_add_f32_dpp v52, v5, v4 row_ror:8 row_mask:0xf bank_mask:0xf
    v_dot2c_f32_bf16 v6, v106, v10
    v_dot2c_f32_bf16 v7, v106, v18
    v_add_f32_dpp v52, v52, v52 row_half_mirror row_mask:0xf bank_mask:0xf
    v_dot2c_f32_bf16 v6, v107, v11
    v_dot2c_f32_bf16 v7, v107, v19
    v_add_f32_dpp v52, v52, v52 quad_perm:[1,0,3,2] row_mask:0xf bank_mask:0xf
    s_bitcmp1_b32 s62, 0
    s_cbranch_scc1 L_th66
    s_waitcnt vmcnt(5)
L_th66:
    buffer_load_dwordx4 v[136:139], v1, s[36:39], s6 offen offset:0 nt
    s_waitcnt vmcnt(7)
    v_dot2c_f32_bf16 v6, v108, v12
    v_dot2c_f32_bf16 v7, v108, v20
    v_add_f32_dpp v52, v52, v52 quad_perm:[2,3,0,1] row_mask:0xf bank_mask:0xf
    v_dot2c_f32_bf16 v6, v109, v13
    v_dot2c_f32_bf16 v7, v109, v21
    v_cvt_pk_bf16_f32 v52, v52, v52
    v_dot2c_f32_bf16 v6, v110, v14
    v_dot2c_f32_bf16 v7, v110, v22
    v_and_b32 v52, 0xffff0000, v52
    v_dot2c_f32_bf16 v6, v111, v15
    v_dot2c_f32_bf16 v7, v111, v23
    s_bitcmp1_b32 s62, 1
    s_cbranch_scc1 L_th67
    s_waitcnt vmcnt(5)
L_th67:
    buffer_load_dwordx4 v[140:143], v1, s[36:39], s6 offen offset:256 nt
    s_add_u32 s6, s6, 0x2000
    s_and_b32 s6, s6, 0x3ffff
    v_mov_b32 v4, 0
    v_mov_b32 v5, 0
    s_waitcnt vmcnt(7)
    v_dot2c_f32_bf16 v4, v112, v8
    v_dot2c_f32_bf16 v5, v112, v16
    v_dot2c_f32_bf16 v4, v113, v9
    v_dot2c_f32_bf16 v5, v113, v17
    v_add_f32_dpp v53, v7, v6 row_ror:8 row_mask:0xf bank_mask:0xf
    v_dot2c_f32_bf16 v4, v114, v10
    v_dot2c_f32_bf16 v5, v114, v18
    v_add_f32_dpp v53, v53, v53 row_half_mirror row_mask:0xf bank_mask:0xf
    v_dot2c_f32_bf16 v4, v115, v11
    v_dot2c_f32_bf16 v5, v115, v19
    v_add_f32_dpp v53, v53, v53 quad_perm:[1,0,3,2] row_mask:0xf bank_mask:0xf
    s_bitcmp1_b32 s62, 0
    s_cbranch_scc1 L_th68
    s_waitcnt vmcnt(5)
L_th68:
    buffer_load_dwordx4 v[144:147], v1, s[36:39], s6 offen offset:0 nt
    s_waitcnt vmcnt(7)
    v_dot2c_f32_bf16 v4, v116, v12
    v_dot2c_f32_bf16 v5, v116, v20
    v_add_f32_dpp v53, v53, v53 quad_perm:[2,3,0,1] row_mask:0xf bank_mask:0xf
    v_dot2c_f32_bf16 v4, v117, v13
    v_dot2c_f32_bf16 v5, v117, v21
    v_cvt_pk_bf16_f32 v53, v53, v53
    v_dot2c_f32_bf16 v4, v118, v14
    v_dot2c_f32_bf16 v5, v118, v22
    v_and_b32 v53, 0xffff0000, v53
    v_dot2c_f32_bf16 v4, v119, v15
    v_dot2c_f32_bf16 v5, v119, v23
    s_bitcmp1_b32 s62, 1
    s_cbranch_scc1 L_th69
    s_waitcnt vmcnt(5)
L_th69:
    buffer_load_dwordx4 v[148:151], v1, s[36:39], s6 offen offset:256 nt
    s_add_u32 s6, s6, 0x2000
    s_and_b32 s6, s6, 0x3ffff
    v_mov_b32 v6, 0
    v_mov_b32 v7, 0
    s_waitcnt vmcnt(7)
    v_dot2c_f32_bf16 v6, v120, v8
    v_dot2c_f32_bf16 v7, v120, v16
    v_dot2c_f32_bf16 v6, v121, v9
    v_dot2c_f32_bf16 v7, v121, v17
    v_add_f32_dpp v54, v5, v4 row_ror:8 row_mask:0xf bank_mask:0xf
    v_dot2c_f32_bf16 v6, v122, v10
    v_dot2c_f32_bf16 v7, v122, v18
    v_add_f32_dpp v54, v54, v54 row_half_mirror row_mask:0xf bank_mask:0xf
    v_dot2c_f32_bf16 v6, v123, v11
    v_dot2c_f32_bf16 v7, v123, v19
    v_add_f32_dpp v54, v54, v54 quad_perm:[1,0,3,2] row_mask:0xf bank_mask:0xf
    s_bitcmp1_b32 s62, 0
    s_cbranch_scc1 L_th70
    s_waitcnt vmcnt(5)
L_th70:
    buffer_load_dwordx4 v[152:155], v1, s[36:39], s6 offen offset:0 nt
    s_waitcnt vmcnt(7)
    v_dot2c_f32_bf16 v6, v124, v12
    v_dot2c_f32_bf16 v7, v124, v20
    v_add_f32_dpp v54, v54, v54 quad_perm:[2,3,0,1] row_mask:0xf bank_mask:0xf
    v_dot2c_f32_bf16 v6, v125, v13
    v_dot2c_f32_bf16 v7, v125, v21
    v_cvt_pk_bf16_f32 v54, v54, v54
    v_dot2c_f32_bf16 v6, v126, v14
    v_dot2c_f32_bf16 v7, v126, v22
    v_and_b32 v54, 0xffff0000, v54
    v_dot2c_f32_bf16 v6, v127, v15
    v_dot2c_f32_bf16 v7, v127, v23
    s_bitcmp1_b32 s62, 1
    s_cbranch_scc1 L_th71
    s_waitcnt vmcnt(5)
L_th71:
    buffer_load_dwordx4 v[156:159], v1, s[36:39], s6 offen offset:256 nt
    s_add_u32 s6, s6, 0x2000
    s_and_b32 s6, s6, 0x3ffff
    s_nop 2
    v_add_f32_dpp v55, v7, v6 row_ror:8 row_mask:0xf bank_mask:0xf
    s_nop 1
    v_add_f32_dpp v55, v55, v55 row_half_mirror row_mask:0xf bank_mask:0xf
    s_nop 1
    v_add_f32_dpp v55, v55, v55 quad_perm:[1,0,3,2] row_mask:0xf bank_mask:0xf
    s_nop 1
    v_add_f32_dpp v55, v55, v55 quad_perm:[2,3,0,1] row_mask:0xf bank_mask:0xf
    s_nop 1
    v_cvt_pk_bf16_f32 v55, v55, v55
    s_nop 1
    v_and_b32 v55, 0xffff0000, v55
    s_nop 1
    v_max3_f32 v4, v24, v25, v26
    v_max3_f32 v5, v27, v28, v29
    v_max3_f32 v4, v4, v30, v31
    v_max3_f32 v5, v5, v32, v33
    v_max3_f32 v4, v4, v34, v35
    v_max3_f32 v5, v5, v36, v37
    v_max3_f32 v4, v4, v38, v39
    v_max3_f32 v5, v5, v40, v41
    v_max3_f32 v4, v4, v42, v43
    v_max3_f32 v5, v5, v44, v45
    v_max3_f32 v4, v4, v46, v47
    v_max3_f32 v5, v5, v48, v49
    v_max3_f32 v4, v4, v50, v51
    v_max3_f32 v5, v5, v52, v53
    v_max3_f32 v4, v4, v54, v55
    v_max_f32 v4, v4, v5
    v_mov_b32 v5, v4
    s_nop 1
    v_permlane16_swap_b32 v4, v5
    s_nop 1
    v_max_f32 v4, v4, v5
    v_mov_b32 v5, v4
    s_nop 1
    v_permlane32_swap_b32 v4, v5
    s_nop 1
    v_max_f32 v4, v4, v5
    v_lshrrev_b32 v6, 3, v2
    v_lshlrev_b32 v6, 4, v6
    s_lshl_b32 s4, s3, 2
    v_add_u32 v7, s4, v6
    ds_write_b32 v7, v4 offset:34288
    s_waitcnt lgkmcnt(0)
    s_barrier
    ds_read_b128 v[8:11], v6 offset:34304
    v_and_b32 v5, 1, v2
    v_lshlrev_b32 v5, 4, v5
    v_mov_b32 v19, 0xffff
    v_lshlrev_b32 v19, v5, v19
    v_bfe_u32 v5, v2, 1, 2
    v_cmp_eq_u32 vcc, 0, v5
    s_nop 1
    v_cndmask_b32 v16, 0, v19, vcc
    v_cmp_eq_u32 vcc, 1, v5
    s_nop 1
    v_cndmask_b32 v17, 0, v19, vcc
    v_cmp_eq_u32 vcc, 2, v5
    s_nop 1
    v_cndmask_b32 v18, 0, v19, vcc
    v_cmp_eq_u32 vcc, 3, v5
    s_nop 1
    v_cndmask_b32 v19, 0, v19, vcc
    v_mov_b32 v56, 0
    v_mov_b32 v57, 0
    v_mov_b32 v58, 0
    v_mov_b32 v59, 0
    v_mov_b32 v60, 0
    v_mov_b32 v61, 0
    v_mov_b32 v62, 0
    v_mov_b32 v63, 0
    s_mov_b32 s4, 1035512379
    s_waitcnt lgkmcnt(0)
    v_max3_f32 v4, v8, v9, v10
    v_max_f32 v4, v4, v11
    v_sub_f32 v24, v24, v4
    v_sub_f32 v25, v25, v4
    v_sub_f32 v26, v26, v4
    v_sub_f32 v27, v27, v4
    v_sub_f32 v28, v28, v4
    v_sub_f32 v29, v29, v4
    v_sub_f32 v30, v30, v4
    v_sub_f32 v31, v31, v4
    v_sub_f32 v32, v32, v4
    v_sub_f32 v33, v33, v4
    v_sub_f32 v34, v34, v4
    v_sub_f32 v35, v35, v4
    v_sub_f32 v36, v36, v4
    v_sub_f32 v37, v37, v4
    v_sub_f32 v38, v38, v4
    v_sub_f32 v39, v39, v4
    v_sub_f32 v40, v40, v4
    v_sub_f32 v41, v41, v4
    v_sub_f32 v42, v42, v4
    v_sub_f32 v43, v43, v4
    v_sub_f32 v44, v44, v4
    v_sub_f32 v45, v45, v4
    v_sub_f32 v46, v46, v4
    v_sub_f32 v47, v47, v4
    v_sub_f32 v48, v48, v4
    v_sub_f32 v49, v49, v4
    v_sub_f32 v50, v50, v4
    v_sub_f32 v51, v51, v4
    v_sub_f32 v52, v52, v4
    v_sub_f32 v53, v53, v4
    v_sub_f32 v54, v54, v4
    v_sub_f32 v55, v55, v4
    v_mul_f32 v24, s4, v24
    v_mul_f32 v25, s4, v25
    v_mul_f32 v26, s4, v26
    v_mul_f32 v27, s4, v27
    v_mul_f32 v28, s4, v28
    v_mul_f32 v29, s4, v29
    v_mul_f32 v30, s4, v30
    v_mul_f32 v31, s4, v31
    v_mul_f32 v32, s4, v32
    v_mul_f32 v33, s4, v33
    v_mul_f32 v34, s4, v34
    v_mul_f32 v35, s4, v35
    v_mul_f32 v36, s4, v36
    v_mul_f32 v37, s4, v37
    v_mul_f32 v38, s4, v38
    v_mul_f32 v39, s4, v39
    v_mul_f32 v40, s4, v40
    v_mul_f32 v41, s4, v41
    v_mul_f32 v42, s4, v42
    v_mul_f32 v43, s4, v43
    v_mul_f32 v44, s4, v44
    v_mul_f32 v45, s4, v45
    v_mul_f32 v46, s4, v46
    v_mul_f32 v47, s4, v47
    v_mul_f32 v48, s4, v48
    v_mul_f32 v49, s4, v49
    v_mul_f32 v50, s4, v50
    v_mul_f32 v51, s4, v51
    v_mul_f32 v52, s4, v52
    v_mul_f32 v53, s4, v53
    v_mul_f32 v54, s4, v54
    v_mul_f32 v55, s4, v55
    v_exp_f32 v24, v24
    v_exp_f32 v25, v25
    v_exp_f32 v26, v26
    v_exp_f32 v27, v27
    v_exp_f32 v28, v28
    v_exp_f32 v29, v29
    v_exp_f32 v30, v30
    v_exp_f32 v31, v31
    v_exp_f32 v32, v32
    v_exp_f32 v33, v33
    v_exp_f32 v34, v34
    v_exp_f32 v35, v35
    v_exp_f32 v36, v36
    v_exp_f32 v37, v37
    v_exp_f32 v38, v38
    v_exp_f32 v39, v39
    v_exp_f32 v40, v40
    v_exp_f32 v41, v41
    v_exp_f32 v42, v42
    v_exp_f32 v43, v43
    v_exp_f32 v44, v44
    v_exp_f32 v45, v45
    v_exp_f32 v46, v46
    v_exp_f32 v47, v47
    v_exp_f32 v48, v48
    v_exp_f32 v49, v49
    v_exp_f32 v50, v50
    v_exp_f32 v51, v51
    v_exp_f32 v52, v52
    v_exp_f32 v53, v53
    v_exp_f32 v54, v54
    v_exp_f32 v55, v55
    v_add_f32 v4, v24, v25
    v_add_f32 v5, v26, v27
    v_add_f32 v4, v4, v28
    v_add_f32 v5, v5, v29
    v_add_f32 v4, v4, v30
    v_add_f32 v5, v5, v31
    v_add_f32 v4, v4, v32
    v_add_f32 v5, v5, v33
    v_add_f32 v4, v4, v34
    v_add_f32 v5, v5, v35
    v_add_f32 v4, v4, v36
    v_add_f32 v5, v5, v37
    v_add_f32 v4, v4, v38
    v_add_f32 v5, v5, v39
    v_add_f32 v4, v4, v40
    v_add_f32 v5, v5, v41
    v_add_f32 v4, v4, v42
    v_add_f32 v5, v5, v43
    v_add_f32 v4, v4, v44
    v_add_f32 v5, v5, v45
    v_add_f32 v4, v4, v46
    v_add_f32 v5, v5, v47
    v_add_f32 v4, v4, v48
    v_add_f32 v5, v5, v49
    v_add_f32 v4, v4, v50
    v_add_f32 v5, v5, v51
    v_add_f32 v4, v4, v52
    v_add_f32 v5, v5, v53
    v_add_f32 v4, v4, v54
    v_add_f32 v5, v5, v55
    v_add_f32 v4, v4, v5
    v_mov_b32 v5, v4
    s_nop 1
    v_permlane16_swap_b32 v4, v5
    s_nop 1
    v_add_f32 v4, v4, v5
    v_mov_b32 v5, v4
    s_nop 1
    v_permlane32_swap_b32 v4, v5
    s_nop 1
    v_add_f32 v4, v4, v5
    ds_write_b32 v7, v4 offset:34320
    v_cvt_pk_bf16_f32 v24, v24, v24
    v_cvt_pk_bf16_f32 v25, v25, v25
    v_cvt_pk_bf16_f32 v26, v26, v26
    v_cvt_pk_bf16_f32 v27, v27, v27
    v_cvt_pk_bf16_f32 v28, v28, v28
    v_cvt_pk_bf16_f32 v29, v29, v29
    v_cvt_pk_bf16_f32 v30, v30, v30
    v_cvt_pk_bf16_f32 v31, v31, v31
    v_cvt_pk_bf16_f32 v32, v32, v32
    v_cvt_pk_bf16_f32 v33, v33, v33
    v_cvt_pk_bf16_f32 v34, v34, v34
    v_cvt_pk_bf16_f32 v35, v35, v35
    v_cvt_pk_bf16_f32 v36, v36, v36
    v_cvt_pk_bf16_f32 v37, v37, v37
    v_cvt_pk_bf16_f32 v38, v38, v38
    v_cvt_pk_bf16_f32 v39, v39, v39
    v_cvt_pk_bf16_f32 v40, v40, v40
    v_cvt_pk_bf16_f32 v41, v41, v41
    v_cvt_pk_bf16_f32 v42, v42, v42
    v_cvt_pk_bf16_f32 v43, v43, v43
    v_cvt_pk_bf16_f32 v44, v44, v44
    v_cvt_pk_bf16_f32 v45, v45, v45
    v_cvt_pk_bf16_f32 v46, v46, v46
    v_cvt_pk_bf16_f32 v47, v47, v47
    v_cvt_pk_bf16_f32 v48, v48, v48
    v_cvt_pk_bf16_f32 v49, v49, v49
    v_cvt_pk_bf16_f32 v50, v50, v50
    v_cvt_pk_bf16_f32 v51, v51, v51
    v_cvt_pk_bf16_f32 v52, v52, v52
    v_cvt_pk_bf16_f32 v53, v53, v53
    v_cvt_pk_bf16_f32 v54, v54, v54
    v_cvt_pk_bf16_f32 v55, v55, v55
    s_waitcnt lgkmcnt(0)
    s_barrier
    v_and_b32 v8, v24, v16
    v_and_b32 v9, v24, v17
    v_and_b32 v10, v24, v18
    v_and_b32 v11, v24, v19
    v_lshrrev_b32 v4, 1, v3
    v_lshlrev_b32 v4, 10, v4
    v_and_b32 v5, 1, v3
    v_lshl_add_u32 v4, v5, 4, v4
    v_lshl_add_u32 v4, v2, 5, v4
    s_lshl_b32 s4, s3, 11
    v_add_u32 v4, s4, v4
    v_and_b32 v12, v25, v16
    v_and_b32 v13, v25, v17
    v_and_b32 v14, v25, v18
    v_and_b32 v15, v25, v19
    s_waitcnt vmcnt(7)
    v_mfma_f32_16x16x32_bf16 v[56:59], v[8:11], v[128:131], v[56:59]
    s_bitcmp1_b32 s62, 0
    s_cbranch_scc1 L_th72
    s_waitcnt vmcnt(5)
L_th72:
    buffer_load_dwordx4 v[160:163], v1, s[36:39], s6 offen offset:0 nt
    s_waitcnt vmcnt(7)
    v_mfma_f32_16x16x32_bf16 v[60:63], v[8:11], v[132:135], v[60:63]
    s_bitcmp1_b32 s62, 1
    s_cbranch_scc1 L_th73
    s_waitcnt vmcnt(5)
L_th73:
    buffer_load_dwordx4 v[164:167], v1, s[36:39], s6 offen offset:256 nt
    s_add_u32 s6, s6, 0x2000
    s_and_b32 s6, s6, 0x3ffff
    v_and_b32 v8, v26, v16
    v_and_b32 v9, v26, v17
    v_and_b32 v10, v26, v18
    v_and_b32 v11, v26, v19
    s_waitcnt vmcnt(7)
    v_mfma_f32_16x16x32_bf16 v[56:59], v[12:15], v[136:139], v[56:59]
    s_bitcmp1_b32 s62, 0
    s_cbranch_scc1 L_th74
    s_waitcnt vmcnt(5)
L_th74:
    buffer_load_dwordx4 v[168:171], v1, s[36:39], s6 offen offset:0 nt
    s_waitcnt vmcnt(7)
    v_mfma_f32_16x16x32_bf16 v[60:63], v[12:15], v[140:143], v[60:63]
    s_bitcmp1_b32 s62, 1
    s_cbranch_scc1 L_th75
    s_waitcnt vmcnt(5)
L_th75:
    buffer_load_dwordx4 v[172:175], v1, s[36:39], s6 offen offset:256 nt
    s_add_u32 s6, s6, 0x2000
    s_and_b32 s6, s6, 0x3ffff
    v_and_b32 v12, v27, v16
    v_and_b32 v13, v27, v17
    v_and_b32 v14, v27, v18
    v_and_b32 v15, v27, v19
    s_waitcnt vmcnt(7)
    v_mfma_f32_16x16x32_bf16 v[56:59], v[8:11], v[144:147], v[56:59]
    s_bitcmp1_b32 s62, 0
    s_cbranch_scc1 L_th76
    s_waitcnt vmcnt(5)
L_th76:
    buffer_load_dwordx4 v[176:179], v1, s[36:39], s6 offen offset:0 nt
    s_waitcnt vmcnt(7)
    v_mfma_f32_16x16x32_bf16 v[60:63], v[8:11], v[148:151], v[60:63]
    s_bitcmp1_b32 s62, 1
    s_cbranch_scc1 L_th77
    s_waitcnt vmcnt(5)
L_th77:
    buffer_load_dwordx4 v[180:183], v1, s[36:39], s6 offen offset:256 nt
    s_add_u32 s6, s6, 0x2000
    s_and_b32 s6, s6, 0x3ffff
    v_and_b32 v8, v28, v16
    v_and_b32 v9, v28, v17
    v_and_b32 v10, v28, v18
    v_and_b32 v11, v28, v19
    s_waitcnt vmcnt(7)
    v_mfma_f32_16x16x32_bf16 v[56:59], v[12:15], v[152:155], v[56:59]
    s_bitcmp1_b32 s62, 0
    s_cbranch_scc1 L_th78
    s_waitcnt vmcnt(5)
L_th78:
    buffer_load_dwordx4 v[184:187], v1, s[36:39], s6 offen offset:0 nt
    s_waitcnt vmcnt(7)
    v_mfma_f32_16x16x32_bf16 v[60:63], v[12:15], v[156:159], v[60:63]
    s_bitcmp1_b32 s62, 1
    s_cbranch_scc1 L_th79
    s_waitcnt vmcnt(5)
L_th79:
    buffer_load_dwordx4 v[188:191], v1, s[36:39], s6 offen offset:256 nt
    s_add_u32 s6, s6, 0x2000
    s_and_b32 s6, s6, 0x3ffff
    v_and_b32 v12, v29, v16
    v_and_b32 v13, v29, v17
    v_and_b32 v14, v29, v18
    v_and_b32 v15, v29, v19
    s_waitcnt vmcnt(7)
    v_mfma_f32_16x16x32_bf16 v[56:59], v[8:11], v[160:163], v[56:59]
    s_bitcmp1_b32 s62, 0
    s_cbranch_scc1 L_th80
    s_waitcnt vmcnt(5)
L_th80:
    buffer_load_dwordx4 v[192:195], v1, s[36:39], s6 offen offset:0 nt
    s_waitcnt vmcnt(7)
    v_mfma_f32_16x16x32_bf16 v[60:63], v[8:11], v[164:167], v[60:63]
    s_bitcmp1_b32 s62, 1
    s_cbranch_scc1 L_th81
    s_waitcnt vmcnt(5)
L_th81:
    buffer_load_dwordx4 v[196:199], v1, s[36:39], s6 offen offset:256 nt
    s_add_u32 s6, s6, 0x2000
    s_and_b32 s6, s6, 0x3ffff
    v_and_b32 v8, v30, v16
    v_and_b32 v9, v30, v17
    v_and_b32 v10, v30, v18
    v_and_b32 v11, v30, v19
    s_waitcnt vmcnt(7)
    v_mfma_f32_16x16x32_bf16 v[56:59], v[12:15], v[168:171], v[56:59]
    s_bitcmp1_b32 s62, 0
    s_cbranch_scc1 L_th82
    s_waitcnt vmcnt(5)
L_th82:
    buffer_load_dwordx4 v[200:203], v1, s[36:39], s6 offen offset:0 nt
    s_waitcnt vmcnt(7)
    v_mfma_f32_16x16x32_bf16 v[60:63], v[12:15], v[172:175], v[60:63]
    s_bitcmp1_b32 s62, 1
    s_cbranch_scc1 L_th83
    s_waitcnt vmcnt(5)
L_th83:
    buffer_load_dwordx4 v[204:207], v1, s[36:39], s6 offen offset:256 nt
    s_add_u32 s6, s6, 0x2000
    s_and_b32 s6, s6, 0x3ffff
    v_and_b32 v12, v31, v16
    v_and_b32 v13, v31, v17
    v_and_b32 v14, v31, v18
    v_and_b32 v15, v31, v19
    s_waitcnt vmcnt(7)
    v_mfma_f32_16x16x32_bf16 v[56:59], v[8:11], v[176:179], v[56:59]
    s_bitcmp1_b32 s62, 0
    s_cbranch_scc1 L_th84
    s_waitcnt vmcnt(5)
L_th84:
    buffer_load_dwordx4 v[208:211], v1, s[36:39], s6 offen offset:0 nt
    s_waitcnt vmcnt(7)
    v_mfma_f32_16x16x32_bf16 v[60:63], v[8:11], v[180:183], v[60:63]
    s_bitcmp1_b32 s62, 1
    s_cbranch_scc1 L_th85
    s_waitcnt vmcnt(5)
L_th85:
    buffer_load_dwordx4 v[212:215], v1, s[36:39], s6 offen offset:256 nt
    s_add_u32 s6, s6, 0x2000
    s_and_b32 s6, s6, 0x3ffff
    v_and_b32 v8, v32, v16
    v_and_b32 v9, v32, v17
    v_and_b32 v10, v32, v18
    v_and_b32 v11, v32, v19
    s_waitcnt vmcnt(7)
    v_mfma_f32_16x16x32_bf16 v[56:59], v[12:15], v[184:187], v[56:59]
    s_bitcmp1_b32 s62, 0
    s_cbranch_scc1 L_th86
    s_waitcnt vmcnt(5)
L_th86:
    buffer_load_dwordx4 v[216:219], v1, s[36:39], s6 offen offset:0 nt
    s_waitcnt vmcnt(7)
    v_mfma_f32_16x16x32_bf16 v[60:63], v[12:15], v[188:191], v[60:63]
    s_bitcmp1_b32 s62, 1
    s_cbranch_scc1 L_th87
    s_waitcnt vmcnt(5)
L_th87:
    buffer_load_dwordx4 v[220:223], v1, s[36:39], s6 offen offset:256 nt
    s_add_u32 s6, s6, 0x2000
    s_and_b32 s6, s6, 0x3ffff
    v_and_b32 v12, v33, v16
    v_and_b32 v13, v33, v17
    v_and_b32 v14, v33, v18
    v_and_b32 v15, v33, v19
    s_waitcnt vmcnt(7)
    v_mfma_f32_16x16x32_bf16 v[56:59], v[8:11], v[192:195], v[56:59]
    s_bitcmp1_b32 s62, 0
    s_cbranch_scc1 L_th88
    s_waitcnt vmcnt(5)
L_th88:
    buffer_load_dwordx4 v[224:227], v1, s[36:39], s6 offen offset:0 nt
    s_waitcnt vmcnt(7)
    v_mfma_f32_16x16x32_bf16 v[60:63], v[8:11], v[196:199], v[60:63]
    s_bitcmp1_b32 s62, 1
    s_cbranch_scc1 L_th89
    s_waitcnt vmcnt(5)
L_th89:
    buffer_load_dwordx4 v[228:231], v1, s[36:39], s6 offen offset:256 nt
    s_add_u32 s6, s6, 0x2000
    s_and_b32 s6, s6, 0x3ffff
    v_and_b32 v8, v34, v16
    v_and_b32 v9, v34, v17
    v_and_b32 v10, v34, v18
    v_and_b32 v11, v34, v19
    s_waitcnt vmcnt(7)
    v_mfma_f32_16x16x32_bf16 v[56:59], v[12:15], v[200:203], v[56:59]
    s_bitcmp1_b32 s62, 0
    s_cbranch_scc1 L_th90
    s_waitcnt vmcnt(5)
L_th90:
    buffer_load_dwordx4 v[232:235], v1, s[36:39], s6 offen offset:0 nt
    s_waitcnt vmcnt(7)
    v_mfma_f32_16x16x32_bf16 v[60:63], v[12:15], v[204:207], v[60:63]
    s_bitcmp1_b32 s62, 1
    s_cbranch_scc1 L_th91
    s_waitcnt vmcnt(5)
L_th91:
    buffer_load_dwordx4 v[236:239], v1, s[36:39], s6 offen offset:256 nt
    s_add_u32 s6, s6, 0x2000
    s_and_b32 s6, s6, 0x3ffff
    v_and_b32 v12, v35, v16
    v_and_b32 v13, v35, v17
    v_and_b32 v14, v35, v18
    v_and_b32 v15, v35, v19
    s_waitcnt vmcnt(7)
    v_mfma_f32_16x16x32_bf16 v[56:59], v[8:11], v[208:211], v[56:59]
    s_bitcmp1_b32 s62, 0
    s_cbranch_scc1 L_th92
    s_waitcnt vmcnt(5)
L_th92:
    buffer_load_dwordx4 v[240:243], v1, s[36:39], s6 offen offset:0 nt
    s_waitcnt vmcnt(7)
    v_mfma_f32_16x16x32_bf16 v[60:63], v[8:11], v[212:215], v[60:63]
    s_bitcmp1_b32 s62, 1
    s_cbranch_scc1 L_th93
    s_waitcnt vmcnt(5)
L_th93:
    buffer_load_dwordx4 v[244:247], v1, s[36:39], s6 offen offset:256 nt
    s_add_u32 s6, s6, 0x2000
    s_and_b32 s6, s6, 0x3ffff
    v_and_b32 v8, v36, v16
    v_and_b32 v9, v36, v17
    v_and_b32 v10, v36, v18
    v_and_b32 v11, v36, v19
    s_waitcnt vmcnt(7)
    v_mfma_f32_16x16x32_bf16 v[56:59], v[12:15], v[216:219], v[56:59]
    s_bitcmp1_b32 s62, 0
    s_cbranch_scc1 L_th94
    s_waitcnt vmcnt(5)
L_th94:
    buffer_load_dwordx4 v[248:251], v1, s[36:39], s6 offen offset:0 nt
    s_waitcnt vmcnt(7)
    v_mfma_f32_16x16x32_bf16 v[60:63], v[12:15], v[220:223], v[60:63]
    s_bitcmp1_b32 s62, 1
    s_cbranch_scc1 L_th95
    s_waitcnt vmcnt(5)
L_th95:
    buffer_load_dwordx4 v[252:255], v1, s[36:39], s6 offen offset:256 nt
    s_add_u32 s6, s6, 0x2000
    s_and_b32 s6, s6, 0x3ffff
    v_and_b32 v12, v37, v16
    v_and_b32 v13, v37, v17
    v_and_b32 v14, v37, v18
    v_and_b32 v15, v37, v19
    s_waitcnt vmcnt(7)
    v_mfma_f32_16x16x32_bf16 v[56:59], v[8:11], v[224:227], v[56:59]
    s_bitcmp1_b32 s62, 0
    s_cbranch_scc1 L_th96
    s_waitcnt vmcnt(5)
L_th96:
    buffer_load_dwordx4 v[64:67], v1, s[36:39], s6 offen offset:0 nt
    s_waitcnt vmcnt(7)
    v_mfma_f32_16x16x32_bf16 v[60:63], v[8:11], v[228:231], v[60:63]
    s_bitcmp1_b32 s62, 1
    s_cbranch_scc1 L_th97
    s_waitcnt vmcnt(5)
L_th97:
    buffer_load_dwordx4 v[68:71], v1, s[36:39], s6 offen offset:256 nt
    s_add_u32 s6, s6, 0x2000
    s_and_b32 s6, s6, 0x3ffff
    v_and_b32 v8, v38, v16
    v_and_b32 v9, v38, v17
    v_and_b32 v10, v38, v18
    v_and_b32 v11, v38, v19
    s_waitcnt vmcnt(7)
    v_mfma_f32_16x16x32_bf16 v[56:59], v[12:15], v[232:235], v[56:59]
    s_bitcmp1_b32 s62, 0
    s_cbranch_scc1 L_th98
    s_waitcnt vmcnt(5)
L_th98:
    buffer_load_dwordx4 v[72:75], v1, s[36:39], s6 offen offset:0 nt
    s_waitcnt vmcnt(7)
    v_mfma_f32_16x16x32_bf16 v[60:63], v[12:15], v[236:239], v[60:63]
    s_bitcmp1_b32 s62, 1
    s_cbranch_scc1 L_th99
    s_waitcnt vmcnt(5)
L_th99:
    buffer_load_dwordx4 v[76:79], v1, s[36:39], s6 offen offset:256 nt
    s_add_u32 s6, s6, 0x2000
    s_and_b32 s6, s6, 0x3ffff
    v_and_b32 v12, v39, v16
    v_and_b32 v13, v39, v17
    v_and_b32 v14, v39, v18
    v_and_b32 v15, v39, v19
    s_waitcnt vmcnt(7)
    v_mfma_f32_16x16x32_bf16 v[56:59], v[8:11], v[240:243], v[56:59]
    s_bitcmp1_b32 s62, 0
    s_cbranch_scc1 L_th100
    s_waitcnt vmcnt(5)
L_th100:
    buffer_load_dwordx4 v[80:83], v1, s[36:39], s6 offen offset:0 nt
    s_waitcnt vmcnt(7)
    v_mfma_f32_16x16x32_bf16 v[60:63], v[8:11], v[244:247], v[60:63]
    s_bitcmp1_b32 s62, 1
    s_cbranch_scc1 L_th101
    s_waitcnt vmcnt(5)
L_th101:
    buffer_load_dwordx4 v[84:87], v1, s[36:39], s6 offen offset:256 nt
    s_add_u32 s6, s6, 0x2000
    s_and_b32 s6, s6, 0x3ffff
    v_and_b32 v8, v40, v16
    v_and_b32 v9, v40, v17
    v_and_b32 v10, v40, v18
    v_and_b32 v11, v40, v19
    s_waitcnt vmcnt(7)
    v_mfma_f32_16x16x32_bf16 v[56:59], v[12:15], v[248:251], v[56:59]
    s_bitcmp1_b32 s62, 0
    s_cbranch_scc1 L_th102
    s_waitcnt vmcnt(5)
L_th102:
    buffer_load_dwordx4 v[88:91], v1, s[36:39], s6 offen offset:0 nt
    s_waitcnt vmcnt(7)
    v_mfma_f32_16x16x32_bf16 v[60:63], v[12:15], v[252:255], v[60:63]
    s_bitcmp1_b32 s62, 1
    s_cbranch_scc1 L_th103
    s_waitcnt vmcnt(5)
L_th103:
    buffer_load_dwordx4 v[92:95], v1, s[36:39], s6 offen offset:256 nt
    s_add_u32 s6, s6, 0x2000
    s_and_b32 s6, s6, 0x3ffff
    v_and_b32 v12, v41, v16
    v_and_b32 v13, v41, v17
    v_and_b32 v14, v41, v18
    v_and_b32 v15, v41, v19
    s_waitcnt vmcnt(7)
    v_mfma_f32_16x16x32_bf16 v[56:59], v[8:11], v[64:67], v[56:59]
    s_bitcmp1_b32 s62, 0
    s_cbranch_scc1 L_th104
    s_waitcnt vmcnt(5)
L_th104:
    buffer_load_dwordx4 v[96:99], v1, s[36:39], s6 offen offset:0 nt
    s_waitcnt vmcnt(7)
    v_mfma_f32_16x16x32_bf16 v[60:63], v[8:11], v[68:71], v[60:63]
    s_bitcmp1_b32 s62, 1
    s_cbranch_scc1 L_th105
    s_waitcnt vmcnt(5)
L_th105:
    buffer_load_dwordx4 v[100:103], v1, s[36:39], s6 offen offset:256 nt
    s_add_u32 s6, s6, 0x2000
    s_and_b32 s6, s6, 0x3ffff
    v_and_b32 v8, v42, v16
    v_and_b32 v9, v42, v17
    v_and_b32 v10, v42, v18
    v_and_b32 v11, v42, v19
    s_waitcnt vmcnt(7)
    v_mfma_f32_16x16x32_bf16 v[56:59], v[12:15], v[72:75], v[56:59]
    s_bitcmp1_b32 s62, 0
    s_cbranch_scc1 L_th106
    s_waitcnt vmcnt(5)
L_th106:
    buffer_load_dwordx4 v[104:107], v1, s[36:39], s6 offen offset:0 nt
    s_waitcnt vmcnt(7)
    v_mfma_f32_16x16x32_bf16 v[60:63], v[12:15], v[76:79], v[60:63]
    s_bitcmp1_b32 s62, 1
    s_cbranch_scc1 L_th107
    s_waitcnt vmcnt(5)
L_th107:
    buffer_load_dwordx4 v[108:111], v1, s[36:39], s6 offen offset:256 nt
    s_add_u32 s6, s6, 0x2000
    s_and_b32 s6, s6, 0x3ffff
    v_and_b32 v12, v43, v16
    v_and_b32 v13, v43, v17
    v_and_b32 v14, v43, v18
    v_and_b32 v15, v43, v19
    s_waitcnt vmcnt(7)
    v_mfma_f32_16x16x32_bf16 v[56:59], v[8:11], v[80:83], v[56:59]
    s_bitcmp1_b32 s62, 0
    s_cbranch_scc1 L_th108
    s_waitcnt vmcnt(5)
L_th108:
    buffer_load_dwordx4 v[112:115], v1, s[36:39], s6 offen offset:0 nt
    s_waitcnt vmcnt(7)
    v_mfma_f32_16x16x32_bf16 v[60:63], v[8:11], v[84:87], v[60:63]
    s_bitcmp1_b32 s62, 1
    s_cbranch_scc1 L_th109
    s_waitcnt vmcnt(5)
L_th109:
    buffer_load_dwordx4 v[116:119], v1, s[36:39], s6 offen offset:256 nt
    s_add_u32 s6, s6, 0x2000
    s_and_b32 s6, s6, 0x3ffff
    v_and_b32 v8, v44, v16
    v_and_b32 v9, v44, v17
    v_and_b32 v10, v44, v18
    v_and_b32 v11, v44, v19
    s_waitcnt vmcnt(7)
    v_mfma_f32_16x16x32_bf16 v[56:59], v[12:15], v[88:91], v[56:59]
    s_bitcmp1_b32 s62, 0
    s_cbranch_scc1 L_th110
    s_waitcnt vmcnt(5)
L_th110:
    buffer_load_dwordx4 v[120:123], v1, s[36:39], s6 offen offset:0 nt
    s_waitcnt vmcnt(7)
    v_mfma_f32_16x16x32_bf16 v[60:63], v[12:15], v[92:95], v[60:63]
    s_bitcmp1_b32 s62, 1
    s_cbranch_scc1 L_th111
    s_waitcnt vmcnt(5)
L_th111:
    buffer_load_dwordx4 v[124:127], v1, s[36:39], s6 offen offset:256 nt
    s_add_u32 s6, s6, 0x2000
    s_and_b32 s6, s6, 0x3ffff
    s_barrier
    v_and_b32 v12, v45, v16
    v_and_b32 v13, v45, v17
    v_and_b32 v14, v45, v18
    v_and_b32 v15, v45, v19
    s_waitcnt vmcnt(7)
    v_mfma_f32_16x16x32_bf16 v[56:59], v[8:11], v[96:99], v[56:59]
    s_bitcmp1_b32 s62, 0
    s_cbranch_scc1 L_th112
    s_waitcnt vmcnt(5)
L_th112:
    buffer_load_dwordx4 v[128:131], v1, s[36:39], s6 offen offset:0 nt
    s_waitcnt vmcnt(7)
    v_mfma_f32_16x16x32_bf16 v[60:63], v[8:11], v[100:103], v[60:63]
    s_bitcmp1_b32 s62, 1
    s_cbranch_scc1 L_th113
    s_waitcnt vmcnt(5)
L_th113:
    buffer_load_dwordx4 v[132:135], v1, s[36:39], s6 offen offset:256 nt
    s_add_u32 s6, s6, 0x2000
    s_and_b32 s6, s6, 0x3ffff
    v_and_b32 v8, v46, v16
    v_and_b32 v9, v46, v17
    v_and_b32 v10, v46, v18
    v_and_b32 v11, v46, v19
    s_waitcnt vmcnt(7)
    v_mfma_f32_16x16x32_bf16 v[56:59], v[12:15], v[104:107], v[56:59]
    s_bitcmp1_b32 s62, 0
    s_cbranch_scc1 L_th114
    s_waitcnt vmcnt(5)
L_th114:
    buffer_load_dwordx4 v[136:139], v1, s[36:39], s6 offen offset:0 nt
    s_waitcnt vmcnt(7)
    v_mfma_f32_16x16x32_bf16 v[60:63], v[12:15], v[108:111], v[60:63]
    s_bitcmp1_b32 s62, 1
    s_cbranch_scc1 L_th115
    s_waitcnt vmcnt(5)
L_th115:
    buffer_load_dwordx4 v[140:143], v1, s[36:39], s6 offen offset:256 nt
    s_add_u32 s6, s6, 0x2000
    s_and_b32 s6, s6, 0x3ffff
    v_and_b32 v12, v47, v16
    v_and_b32 v13, v47, v17
    v_and_b32 v14, v47, v18
    v_and_b32 v15, v47, v19
    s_waitcnt vmcnt(7)
    v_mfma_f32_16x16x32_bf16 v[56:59], v[8:11], v[112:115], v[56:59]
    s_bitcmp1_b32 s62, 0
    s_cbranch_scc1 L_th116
    s_waitcnt vmcnt(5)
L_th116:
    buffer_load_dwordx4 v[144:147], v1, s[36:39], s6 offen offset:0 nt
    s_waitcnt vmcnt(7)
    v_mfma_f32_16x16x32_bf16 v[60:63], v[8:11], v[116:119], v[60:63]
    s_bitcmp1_b32 s62, 1
    s_cbranch_scc1 L_th117
    s_waitcnt vmcnt(5)
L_th117:
    buffer_load_dwordx4 v[148:151], v1, s[36:39], s6 offen offset:256 nt
    s_add_u32 s6, s6, 0x2000
    s_and_b32 s6, s6, 0x3ffff
    v_and_b32 v8, v48, v16
    v_and_b32 v9, v48, v17
    v_and_b32 v10, v48, v18
    v_and_b32 v11, v48, v19
    s_waitcnt vmcnt(7)
    v_mfma_f32_16x16x32_bf16 v[56:59], v[12:15], v[120:123], v[56:59]
    s_bitcmp1_b32 s62, 0
    s_cbranch_scc1 L_th118
    s_waitcnt vmcnt(5)
L_th118:
    buffer_load_dwordx4 v[152:155], v1, s[36:39], s6 offen offset:0 nt
    s_waitcnt vmcnt(7)
    v_mfma_f32_16x16x32_bf16 v[60:63], v[12:15], v[124:127], v[60:63]
    s_bitcmp1_b32 s62, 1
    s_cbranch_scc1 L_th119
    s_waitcnt vmcnt(5)
L_th119:
    buffer_load_dwordx4 v[156:159], v1, s[36:39], s6 offen offset:256 nt
    s_add_u32 s6, s6, 0x2000
    s_and_b32 s6, s6, 0x3ffff
    v_and_b32 v12, v49, v16
    v_and_b32 v13, v49, v17
    v_and_b32 v14, v49, v18
    v_and_b32 v15, v49, v19
    s_waitcnt vmcnt(7)
    v_mfma_f32_16x16x32_bf16 v[56:59], v[8:11], v[128:131], v[56:59]
    s_bitcmp1_b32 s62, 0
    s_cbranch_scc1 L_th120
    s_waitcnt vmcnt(5)
L_th120:
    buffer_load_dwordx4 v[160:163], v1, s[36:39], s6 offen offset:0 nt
    s_waitcnt vmcnt(7)
    v_mfma_f32_16x16x32_bf16 v[60:63], v[8:11], v[132:135], v[60:63]
    s_bitcmp1_b32 s62, 1
    s_cbranch_scc1 L_th121
    s_waitcnt vmcnt(5)
L_th121:
    buffer_load_dwordx4 v[164:167], v1, s[36:39], s6 offen offset:256 nt
    s_add_u32 s6, s6, 0x2000
    s_and_b32 s6, s6, 0x3ffff
    v_and_b32 v8, v50, v16
    v_and_b32 v9, v50, v17
    v_and_b32 v10, v50, v18
    v_and_b32 v11, v50, v19
    s_waitcnt vmcnt(7)
    v_mfma_f32_16x16x32_bf16 v[56:59], v[12:15], v[136:139], v[56:59]
    s_bitcmp1_b32 s62, 0
    s_cbranch_scc1 L_th122
    s_waitcnt vmcnt(5)
L_th122:
    buffer_load_dwordx4 v[168:171], v1, s[36:39], s6 offen offset:0 nt
    s_waitcnt vmcnt(7)
    v_mfma_f32_16x16x32_bf16 v[60:63], v[12:15], v[140:143], v[60:63]
    s_bitcmp1_b32 s62, 1
    s_cbranch_scc1 L_th123
    s_waitcnt vmcnt(5)
L_th123:
    buffer_load_dwordx4 v[172:175], v1, s[36:39], s6 offen offset:256 nt
    s_add_u32 s6, s6, 0x2000
    s_and_b32 s6, s6, 0x3ffff
    v_and_b32 v12, v51, v16
    v_and_b32 v13, v51, v17
    v_and_b32 v14, v51, v18
    v_and_b32 v15, v51, v19
    s_waitcnt vmcnt(7)
    v_mfma_f32_16x16x32_bf16 v[56:59], v[8:11], v[144:147], v[56:59]
    s_bitcmp1_b32 s62, 0
    s_cbranch_scc1 L_th124
    s_waitcnt vmcnt(5)
L_th124:
    buffer_load_dwordx4 v[176:179], v1, s[36:39], s6 offen offset:0 nt
    s_waitcnt vmcnt(7)
    v_mfma_f32_16x16x32_bf16 v[60:63], v[8:11], v[148:151], v[60:63]
    s_bitcmp1_b32 s62, 1
    s_cbranch_scc1 L_th125
    s_waitcnt vmcnt(5)
L_th125:
    buffer_load_dwordx4 v[180:183], v1, s[36:39], s6 offen offset:256 nt
    s_add_u32 s6, s6, 0x2000
    s_and_b32 s6, s6, 0x3ffff
    s_barrier
    v_and_b32 v8, v52, v16
    v_and_b32 v9, v52, v17
    v_and_b32 v10, v52, v18
    v_and_b32 v11, v52, v19
    s_waitcnt vmcnt(7)
    v_mfma_f32_16x16x32_bf16 v[56:59], v[12:15], v[152:155], v[56:59]
    s_bitcmp1_b32 s62, 0
    s_cbranch_scc1 L_th126
    s_waitcnt vmcnt(5)
L_th126:
    buffer_load_dwordx4 v[184:187], v1, s[36:39], s6 offen offset:0 nt
    s_waitcnt vmcnt(7)
    v_mfma_f32_16x16x32_bf16 v[60:63], v[12:15], v[156:159], v[60:63]
    s_bitcmp1_b32 s62, 1
    s_cbranch_scc1 L_th127
    s_waitcnt vmcnt(5)
L_th127:
    buffer_load_dwordx4 v[188:191], v1, s[36:39], s6 offen offset:256 nt
    s_add_u32 s6, s6, 0x2000
    s_and_b32 s6, s6, 0x3ffff
    v_and_b32 v12, v53, v16
    v_and_b32 v13, v53, v17
    v_and_b32 v14, v53, v18
    v_and_b32 v15, v53, v19
    s_waitcnt vmcnt(7)
    v_mfma_f32_16x16x32_bf16 v[56:59], v[8:11], v[160:163], v[56:59]
    s_waitcnt vmcnt(6)
    v_mfma_f32_16x16x32_bf16 v[60:63], v[8:11], v[164:167], v[60:63]
    v_and_b32 v8, v54, v16
    v_and_b32 v9, v54, v17
    v_and_b32 v10, v54, v18
    v_and_b32 v11, v54, v19
    s_waitcnt vmcnt(5)
    v_mfma_f32_16x16x32_bf16 v[56:59], v[12:15], v[168:171], v[56:59]
    s_waitcnt vmcnt(4)
    v_mfma_f32_16x16x32_bf16 v[60:63], v[12:15], v[172:175], v[60:63]
    v_and_b32 v12, v55, v16
    v_and_b32 v13, v55, v17
    v_and_b32 v14, v55, v18
    v_and_b32 v15, v55, v19
    s_waitcnt vmcnt(3)
    v_mfma_f32_16x16x32_bf16 v[56:59], v[8:11], v[176:179], v[56:59]
    s_waitcnt vmcnt(2)
    v_mfma_f32_16x16x32_bf16 v[60:63], v[8:11], v[180:183], v[60:63]
    s_waitcnt vmcnt(1)
    v_mfma_f32_16x16x32_bf16 v[56:59], v[12:15], v[184:187], v[56:59]
    s_waitcnt vmcnt(0)
    v_mfma_f32_16x16x32_bf16 v[60:63], v[12:15], v[188:191], v[60:63]
    s_nop 6
    ds_write_b128 v4, v[56:59] offset:26624
    ds_write_b128 v4, v[60:63] offset:27136
    s_waitcnt lgkmcnt(0)
    s_barrier
    s_cmp_lg_u32 s3, 4
    s_cbranch_scc1 L_fin
    s_cmpk_ge_u32 s2, 128
    s_cbranch_scc1 L_fin
    s_and_b32 s4, s2, 0x62
    s_cmp_eq_u32 s4, 0x62
    s_cbranch_scc1 L_fin
    s_mov_b32 s32, s30
    s_mov_b32 s33, s31
    s_mov_b32 s34, 4194304
    s_mov_b32 s35, 0x20000
    s_lshl_b32 s4, s2, 12
    v_lshlrev_b32 v1, 4, v0
    s_add_u32 s48, s4, 1048576
    s_add_u32 s49, s4, 1049600
    s_add_u32 s50, s4, 1050624
    s_add_u32 s51, s4, 1051648
    s_and_b32 s41, s7, 1023
    s_bfe_u32 s42, s2, 0x20003
    s_mul_i32 s42, s42, 896
    s_lshr_b32 s43, s2, 5
    s_lshl_b32 s43, s43, 8
    s_add_u32 s42, s42, s43
    s_and_b32 s43, s2, 3
    s_lshl_b32 s43, s43, 6
    s_add_u32 s42, s42, s43
    s_and_b32 s43, s2, 4
    s_lshl_b32 s43, s43, 1
    s_add_u32 s42, s42, s43
    v_and_b32 v4, 3, v0
    v_lshlrev_b32 v4, 4, v4
    s_mov_b32 s36, s8
    s_mov_b32 s37, s9
    s_mov_b32 s38, 3584
    s_mov_b32 s39, 0x20000
    s_mov_b32 s44, s26
    s_mov_b32 s45, s27
    s_mov_b32 s46, 3584
    s_mov_b32 s47, 0x20000
    buffer_load_dwordx2 v[6:7], v4, s[36:39], s42 offen
    s_mov_b32 s43, 4294966272
    v_and_b32 v5, 7, v0
    v_lshlrev_b32 v5, 2, v5
    s_lshr_b32 s5, s2, 3
    s_and_b32 s5, s5, 0
    s_lshl_b32 s5, s5, 7
    v_add_u32 v5, s5, v5
    s_setprio 3
    s_barrier
    s_movk_i32 s40, 2048
L_g2:
    buffer_load_dword v8, v5, s[32:35], 0 offen offset:2304 sc1
    s_sub_u32 s40, s40, 1
    s_cbranch_scc1 L_g2_x
    s_waitcnt vmcnt(0)
    v_cmp_ne_u32 vcc, s7, v8
    s_cbranch_vccnz L_g2
L_g2_x:
    s_mov_b64 s[80:81], -1
    s_mov_b64 s[82:83], -1
    s_mov_b64 s[84:85], -1
    s_mov_b64 s[86:87], -1
    s_mov_b32 s40, 1048576
L_p2:
    s_mov_b64 exec, s[80:81]
    s_cbranch_execz L_p2_s0
    buffer_load_dwordx4 v[8:11], v1, s[32:35], s48 offen sc1
L_p2_s0:
    s_mov_b64 exec, s[82:83]
    s_cbranch_execz L_p2_s1
    buffer_load_dwordx4 v[12:15], v1, s[32:35], s49 offen sc1
L_p2_s1:
    s_mov_b64 exec, s[84:85]
    s_cbranch_execz L_p2_s2
    buffer_load_dwordx4 v[16:19], v1, s[32:35], s50 offen sc1
L_p2_s2:
    s_mov_b64 exec, s[86:87]
    s_cbranch_execz L_p2_s3
    buffer_load_dwordx4 v[20:23], v1, s[32:35], s51 offen sc1
L_p2_s3:
    s_sub_u32 s40, s40, 1
    s_cselect_b64 s[90:91], 0, -1
    s_mov_b64 exec, s[80:81]
    s_waitcnt vmcnt(0)
    v_xor_b32 v5, s41, v8
    v_bitop3_b32 v5, v9, s41, v5 bitop3:0xbe
    v_bitop3_b32 v5, v10, s41, v5 bitop3:0xbe
    v_bitop3_b32 v5, v11, s41, v5 bitop3:0xbe
    v_and_b32 v5, 1023, v5
    v_cmp_ne_u32 s[80:81], 0, v5
    s_mov_b64 exec, s[82:83]
    v_xor_b32 v5, s41, v12
    v_bitop3_b32 v5, v13, s41, v5 bitop3:0xbe
    v_bitop3_b32 v5, v14, s41, v5 bitop3:0xbe
    v_bitop3_b32 v5, v15, s41, v5 bitop3:0xbe
    v_and_b32 v5, 1023, v5
    v_cmp_ne_u32 s[82:83], 0, v5
    s_mov_b64 exec, s[84:85]
    v_xor_b32 v5, s41, v16
    v_bitop3_b32 v5, v17, s41, v5 bitop3:0xbe
    v_bitop3_b32 v5, v18, s41, v5 bitop3:0xbe
    v_bitop3_b32 v5, v19, s41, v5 bitop3:0xbe
    v_and_b32 v5, 1023, v5
    v_cmp_ne_u32 s[84:85], 0, v5
    s_mov_b64 exec, s[86:87]
    v_xor_b32 v5, s41, v20
    v_bitop3_b32 v5, v21, s41, v5 bitop3:0xbe
    v_bitop3_b32 v5, v22, s41, v5 bitop3:0xbe
    v_bitop3_b32 v5, v23, s41, v5 bitop3:0xbe
    v_and_b32 v5, 1023, v5
    v_cmp_ne_u32 s[86:87], 0, v5
    s_or_b64 s[88:89], s[80:81], s[82:83]
    s_or_b64 s[88:89], s[88:89], s[84:85]
    s_or_b64 s[88:89], s[88:89], s[86:87]
    s_and_b64 s[88:89], s[88:89], s[90:91]
    s_cbranch_scc1 L_p2
    s_mov_b64 exec, -1
    v_and_b32 v8, s43, v8
    v_and_b32 v9, s43, v9
    v_and_b32 v10, s43, v10
    v_and_b32 v11, s43, v11
    v_and_b32 v12, s43, v12
    v_and_b32 v13, s43, v13
    v_and_b32 v14, s43, v14
    v_and_b32 v15, s43, v15
    v_and_b32 v16, s43, v16
    v_and_b32 v17, s43, v17
    v_and_b32 v18, s43, v18
    v_and_b32 v19, s43, v19
    v_and_b32 v20, s43, v20
    v_and_b32 v21, s43, v21
    v_and_b32 v22, s43, v22
    v_and_b32 v23, s43, v23
    v_pk_add_f32 v[8:9], v[8:9], v[12:13]
    v_pk_add_f32 v[10:11], v[10:11], v[14:15]
    v_pk_add_f32 v[16:17], v[16:17], v[20:21]
    v_pk_add_f32 v[18:19], v[18:19], v[22:23]
    v_pk_add_f32 v[8:9], v[8:9], v[16:17]
    v_pk_add_f32 v[10:11], v[10:11], v[18:19]
    v_lshlrev_b32 v24, 16, v6
    v_and_b32 v25, 0xffff0000, v6
    v_lshlrev_b32 v26, 16, v7
    v_and_b32 v27, 0xffff0000, v7
    v_add_f32_dpp v8, v8, v8 row_ror:4 row_mask:0xf bank_mask:0xf
    v_add_f32_dpp v9, v9, v9 row_ror:4 row_mask:0xf bank_mask:0xf
    v_add_f32_dpp v10, v10, v10 row_ror:4 row_mask:0xf bank_mask:0xf
    v_add_f32_dpp v11, v11, v11 row_ror:4 row_mask:0xf bank_mask:0xf
    v_add_f32_dpp v8, v8, v8 row_ror:8 row_mask:0xf bank_mask:0xf
    v_add_f32_dpp v9, v9, v9 row_ror:8 row_mask:0xf bank_mask:0xf
    v_add_f32_dpp v10, v10, v10 row_ror:8 row_mask:0xf bank_mask:0xf
    v_add_f32_dpp v11, v11, v11 row_ror:8 row_mask:0xf bank_mask:0xf
    v_mov_b32 v12, v8
    v_mov_b32 v13, v9
    v_mov_b32 v14, v10
    v_mov_b32 v15, v11
    s_nop 1
    v_permlane16_swap_b32 v8, v12
    v_permlane16_swap_b32 v9, v13
    v_permlane16_swap_b32 v10, v14
    v_permlane16_swap_b32 v11, v15
    s_nop 1
    v_add_f32 v8, v8, v12
    v_add_f32 v9, v9, v13
    v_add_f32 v10, v10, v14
    v_add_f32 v11, v11, v15
    v_mov_b32 v12, v8
    v_mov_b32 v13, v9
    v_mov_b32 v14, v10
    v_mov_b32 v15, v11
    s_nop 1
    v_permlane32_swap_b32 v8, v12
    v_permlane32_swap_b32 v9, v13
    v_permlane32_swap_b32 v10, v14
    v_permlane32_swap_b32 v11, v15
    s_nop 1
    v_add_f32 v8, v8, v12
    v_add_f32 v9, v9, v13
    v_add_f32 v10, v10, v14
    v_add_f32 v11, v11, v15
    v_pk_add_f32 v[8:9], v[8:9], v[24:25]
    v_pk_add_f32 v[10:11], v[10:11], v[26:27]
    v_cvt_pk_bf16_f32 v8, v8, v9
    v_cvt_pk_bf16_f32 v9, v10, v11
    s_mov_b64 exec, 15
    buffer_store_dwordx2 v[8:9], v4, s[44:47], s42 offen sc1
    s_cmp_lg_u32 s2, 0
    s_cbranch_scc1 L_fin
    s_mov_b64 exec, 1
    v_mov_b32 v5, s7
    buffer_store_dword v5, v4, s[32:35], 0 offen sc1
L_fin:
L_end:
    s_endpgm
L_ln:
    s_load_dword s7, s[30:31], 0
    s_mov_b32 s56, s30
    s_mov_b32 s57, s31
    s_mov_b32 s58, 4194304
    s_mov_b32 s59, 0x20000
    s_waitcnt vmcnt(28)
    v_lshlrev_b32 v80, 16, v64
    v_and_b32 v81, 0xffff0000, v64
    v_lshlrev_b32 v82, 16, v65
    v_and_b32 v83, 0xffff0000, v65
    v_lshlrev_b32 v84, 16, v66
    v_and_b32 v85, 0xffff0000, v66
    v_lshlrev_b32 v86, 16, v67
    v_and_b32 v87, 0xffff0000, v67
    v_lshlrev_b32 v88, 16, v68
    v_and_b32 v89, 0xffff0000, v68
    v_lshlrev_b32 v90, 16, v69
    v_and_b32 v91, 0xffff0000, v69
    v_lshlrev_b32 v92, 16, v70
    v_and_b32 v93, 0xffff0000, v70
    v_lshlrev_b32 v94, 16, v71
    v_and_b32 v95, 0xffff0000, v71
    v_lshlrev_b32 v96, 16, v72
    v_and_b32 v97, 0xffff0000, v72
    v_lshlrev_b32 v98, 16, v73
    v_and_b32 v99, 0xffff0000, v73
    v_lshlrev_b32 v100, 16, v74
    v_and_b32 v101, 0xffff0000, v74
    v_lshlrev_b32 v102, 16, v75
    v_and_b32 v103, 0xffff0000, v75
    v_lshlrev_b32 v104, 16, v76
    v_and_b32 v105, 0xffff0000, v76
    v_lshlrev_b32 v106, 16, v77
    v_and_b32 v107, 0xffff0000, v77
    v_pk_add_f32 v[8:9], v[80:81], v[82:83]
    v_pk_add_f32 v[8:9], v[8:9], v[84:85]
    v_pk_add_f32 v[8:9], v[8:9], v[86:87]
    v_pk_add_f32 v[8:9], v[8:9], v[88:89]
    v_pk_add_f32 v[8:9], v[8:9], v[90:91]
    v_pk_add_f32 v[8:9], v[8:9], v[92:93]
    v_pk_add_f32 v[8:9], v[8:9], v[94:95]
    v_pk_add_f32 v[8:9], v[8:9], v[96:97]
    v_pk_add_f32 v[8:9], v[8:9], v[98:99]
    v_pk_add_f32 v[8:9], v[8:9], v[100:101]
    v_pk_add_f32 v[8:9], v[8:9], v[102:103]
    v_pk_add_f32 v[8:9], v[8:9], v[104:105]
    v_pk_add_f32 v[8:9], v[8:9], v[106:107]
    v_add_f32 v8, v8, v9
    s_nop 1
    v_add_f32_dpp v8, v8, v8 row_ror:8 row_mask:0xf bank_mask:0xf
    s_nop 1
    v_add_f32_dpp v8, v8, v8 row_ror:4 row_mask:0xf bank_mask:0xf
    s_nop 1
    v_add_f32_dpp v8, v8, v8 row_ror:2 row_mask:0xf bank_mask:0xf
    s_nop 1
    v_add_f32_dpp v8, v8, v8 row_ror:1 row_mask:0xf bank_mask:0xf
    v_mul_f32 v8, 0x3b124925, v8
    v_mov_b32 v10, 0
    v_mov_b32 v11, 0
    v_sub_f32 v12, v80, v8
    v_sub_f32 v13, v81, v8
    v_fmac_f32 v10, v12, v12
    v_fmac_f32 v11, v13, v13
    v_sub_f32 v12, v82, v8
    v_sub_f32 v13, v83, v8
    v_fmac_f32 v10, v12, v12
    v_fmac_f32 v11, v13, v13
    v_sub_f32 v12, v84, v8
    v_sub_f32 v13, v85, v8
    v_fmac_f32 v10, v12, v12
    v_fmac_f32 v11, v13, v13
    v_sub_f32 v12, v86, v8
    v_sub_f32 v13, v87, v8
    v_fmac_f32 v10, v12, v12
    v_fmac_f32 v11, v13, v13
    v_sub_f32 v12, v88, v8
    v_sub_f32 v13, v89, v8
    v_fmac_f32 v10, v12, v12
    v_fmac_f32 v11, v13, v13
    v_sub_f32 v12, v90, v8
    v_sub_f32 v13, v91, v8
    v_fmac_f32 v10, v12, v12
    v_fmac_f32 v11, v13, v13
    v_sub_f32 v12, v92, v8
    v_sub_f32 v13, v93, v8
    v_fmac_f32 v10, v12, v12
    v_fmac_f32 v11, v13, v13
    v_sub_f32 v12, v94, v8
    v_sub_f32 v13, v95, v8
    v_fmac_f32 v10, v12, v12
    v_fmac_f32 v11, v13, v13
    v_sub_f32 v12, v96, v8
    v_sub_f32 v13, v97, v8
    v_fmac_f32 v10, v12, v12
    v_fmac_f32 v11, v13, v13
    v_sub_f32 v12, v98, v8
    v_sub_f32 v13, v99, v8
    v_fmac_f32 v10, v12, v12
    v_fmac_f32 v11, v13, v13
    v_sub_f32 v12, v100, v8
    v_sub_f32 v13, v101, v8
    v_fmac_f32 v10, v12, v12
    v_fmac_f32 v11, v13, v13
    v_sub_f32 v12, v102, v8
    v_sub_f32 v13, v103, v8
    v_fmac_f32 v10, v12, v12
    v_fmac_f32 v11, v13, v13
    v_sub_f32 v12, v104, v8
    v_sub_f32 v13, v105, v8
    v_fmac_f32 v10, v12, v12
    v_fmac_f32 v11, v13, v13
    v_sub_f32 v12, v106, v8
    v_sub_f32 v13, v107, v8
    v_fmac_f32 v10, v12, v12
    v_fmac_f32 v11, v13, v13
    v_add_f32 v10, v10, v11
    s_nop 1
    v_add_f32_dpp v10, v10, v10 row_ror:8 row_mask:0xf bank_mask:0xf
    s_nop 1
    v_add_f32_dpp v10, v10, v10 row_ror:4 row_mask:0xf bank_mask:0xf
    s_nop 1
    v_add_f32_dpp v10, v10, v10 row_ror:2 row_mask:0xf bank_mask:0xf
    s_nop 1
    v_add_f32_dpp v10, v10, v10 row_ror:1 row_mask:0xf bank_mask:0xf
    v_mul_f32 v10, 0x3b124925, v10
    v_cvt_pk_bf16_f32 v8, v8, v10
    v_and_b32 v10, 0xffff0000, v8
    v_lshlrev_b32 v8, 16, v8
    v_add_f32 v10, 0x3727c5ac, v10
    v_cvt_pk_bf16_f32 v10, v10, v10
    v_and_b32 v10, 0xffff0000, v10
    v_sqrt_f32 v10, v10
    s_nop 0
    v_cvt_pk_bf16_f32 v10, v10, v10
    v_and_b32 v10, 0xffff0000, v10
    v_rcp_f32 v10, v10
    s_mul_i32 s55, s54, 448
    v_sub_f32 v80, v80, v8
    v_sub_f32 v81, v81, v8
    v_cvt_pk_bf16_f32 v80, v80, v81
    v_and_b32 v81, 0xffff0000, v80
    v_lshlrev_b32 v80, 16, v80
    v_mul_f32 v80, v80, v10
    v_mul_f32 v81, v81, v10
    v_cvt_pk_bf16_f32 v64, v80, v81
    v_sub_f32 v82, v82, v8
    v_sub_f32 v83, v83, v8
    v_cvt_pk_bf16_f32 v82, v82, v83
    v_and_b32 v83, 0xffff0000, v82
    v_lshlrev_b32 v82, 16, v82
    v_mul_f32 v82, v82, v10
    v_mul_f32 v83, v83, v10
    v_cvt_pk_bf16_f32 v65, v82, v83
    v_sub_f32 v84, v84, v8
    v_sub_f32 v85, v85, v8
    v_cvt_pk_bf16_f32 v84, v84, v85
    v_and_b32 v85, 0xffff0000, v84
    v_lshlrev_b32 v84, 16, v84
    v_mul_f32 v84, v84, v10
    v_mul_f32 v85, v85, v10
    v_cvt_pk_bf16_f32 v66, v84, v85
    v_sub_f32 v86, v86, v8
    v_sub_f32 v87, v87, v8
    v_cvt_pk_bf16_f32 v86, v86, v87
    v_and_b32 v87, 0xffff0000, v86
    v_lshlrev_b32 v86, 16, v86
    v_mul_f32 v86, v86, v10
    v_mul_f32 v87, v87, v10
    v_cvt_pk_bf16_f32 v67, v86, v87
    v_sub_f32 v88, v88, v8
    v_sub_f32 v89, v89, v8
    v_cvt_pk_bf16_f32 v88, v88, v89
    v_and_b32 v89, 0xffff0000, v88
    v_lshlrev_b32 v88, 16, v88
    v_mul_f32 v88, v88, v10
    v_mul_f32 v89, v89, v10
    v_cvt_pk_bf16_f32 v68, v88, v89
    v_sub_f32 v90, v90, v8
    v_sub_f32 v91, v91, v8
    v_cvt_pk_bf16_f32 v90, v90, v91
    v_and_b32 v91, 0xffff0000, v90
    v_lshlrev_b32 v90, 16, v90
    v_mul_f32 v90, v90, v10
    v_mul_f32 v91, v91, v10
    v_cvt_pk_bf16_f32 v69, v90, v91
    v_sub_f32 v92, v92, v8
    v_sub_f32 v93, v93, v8
    v_cvt_pk_bf16_f32 v92, v92, v93
    v_and_b32 v93, 0xffff0000, v92
    v_lshlrev_b32 v92, 16, v92
    v_mul_f32 v92, v92, v10
    v_mul_f32 v93, v93, v10
    v_cvt_pk_bf16_f32 v70, v92, v93
    v_sub_f32 v94, v94, v8
    v_sub_f32 v95, v95, v8
    v_cvt_pk_bf16_f32 v94, v94, v95
    v_and_b32 v95, 0xffff0000, v94
    v_lshlrev_b32 v94, 16, v94
    v_mul_f32 v94, v94, v10
    v_mul_f32 v95, v95, v10
    v_cvt_pk_bf16_f32 v71, v94, v95
    v_sub_f32 v96, v96, v8
    v_sub_f32 v97, v97, v8
    v_cvt_pk_bf16_f32 v96, v96, v97
    v_and_b32 v97, 0xffff0000, v96
    v_lshlrev_b32 v96, 16, v96
    v_mul_f32 v96, v96, v10
    v_mul_f32 v97, v97, v10
    v_cvt_pk_bf16_f32 v72, v96, v97
    v_sub_f32 v98, v98, v8
    v_sub_f32 v99, v99, v8
    v_cvt_pk_bf16_f32 v98, v98, v99
    v_and_b32 v99, 0xffff0000, v98
    v_lshlrev_b32 v98, 16, v98
    v_mul_f32 v98, v98, v10
    v_mul_f32 v99, v99, v10
    v_cvt_pk_bf16_f32 v73, v98, v99
    v_sub_f32 v100, v100, v8
    v_sub_f32 v101, v101, v8
    v_cvt_pk_bf16_f32 v100, v100, v101
    v_and_b32 v101, 0xffff0000, v100
    v_lshlrev_b32 v100, 16, v100
    v_mul_f32 v100, v100, v10
    v_mul_f32 v101, v101, v10
    v_cvt_pk_bf16_f32 v74, v100, v101
    v_sub_f32 v102, v102, v8
    v_sub_f32 v103, v103, v8
    v_cvt_pk_bf16_f32 v102, v102, v103
    v_and_b32 v103, 0xffff0000, v102
    v_lshlrev_b32 v102, 16, v102
    v_mul_f32 v102, v102, v10
    v_mul_f32 v103, v103, v10
    v_cvt_pk_bf16_f32 v75, v102, v103
    v_sub_f32 v104, v104, v8
    v_sub_f32 v105, v105, v8
    v_cvt_pk_bf16_f32 v104, v104, v105
    v_and_b32 v105, 0xffff0000, v104
    v_lshlrev_b32 v104, 16, v104
    v_mul_f32 v104, v104, v10
    v_mul_f32 v105, v105, v10
    v_cvt_pk_bf16_f32 v76, v104, v105
    v_sub_f32 v106, v106, v8
    v_sub_f32 v107, v107, v8
    v_cvt_pk_bf16_f32 v106, v106, v107
    v_and_b32 v107, 0xffff0000, v106
    v_lshlrev_b32 v106, 16, v106
    v_mul_f32 v106, v106, v10
    v_mul_f32 v107, v107, v10
    v_cvt_pk_bf16_f32 v77, v106, v107
    ds_write_b64 v4, v[64:65] offset:28672
    ds_write_b64 v4, v[66:67] offset:28800
    ds_write_b64 v4, v[68:69] offset:28928
    ds_write_b64 v4, v[70:71] offset:29056
    ds_write_b64 v4, v[72:73] offset:29184
    ds_write_b64 v4, v[74:75] offset:29312
    ds_write_b64 v4, v[76:77] offset:29440
    v_and_b32 v5, 3, v2
    v_lshlrev_b32 v6, 3, v5
    v_mul_u32_u24 v5, 896, v5
    v_lshl_add_u32 v5, v3, 4, v5
    v_add_u32 v5, s55, v5
    v_lshrrev_b32 v7, 2, v2
    v_lshl_add_u32 v6, v7, 7, v6
    v_lshl_add_u32 v6, v3, 10, v6
    v_lshrrev_b32 v7, 3, v2
    v_lshl_add_u32 v6, v7, 5, v6
    v_and_b32 v7, 1, v3
    v_lshl_add_u32 v56, v7, 6, v6
    v_xor_b32 v57, 32, v56
    v_xor_b32 v58, 64, v56
    v_xor_b32 v59, 96, v56
    s_waitcnt lgkmcnt(0)
    ds_read_b128 v[64:67], v5 offset:28672
    ds_read_b128 v[68:71], v5 offset:28736
    ds_read_b128 v[72:75], v5 offset:28800
    ds_read_b128 v[76:79], v5 offset:28864
    ds_read_b128 v[80:83], v5 offset:28928
    ds_read_b128 v[84:87], v5 offset:28992
    ds_read_b128 v[88:91], v5 offset:29056
    s_add_u32 s7, s7, 1
    s_and_b32 s41, s7, 63
    s_mov_b32 s43, 4294967232
    v_lshrrev_b32 v7, 2, v2
    v_cmp_eq_u32 vcc, 1, v7
    v_cmp_eq_u32 s[44:45], 2, v7
    v_cmp_eq_u32 s[46:47], 3, v7
    v_mov_b32 v7, s41
    s_waitcnt vmcnt(24)
    ds_read_b64_tr_b16 v[96:97], v56 offset:0
    ds_read_b64_tr_b16 v[98:99], v56 offset:512
    ds_read_b64_tr_b16 v[100:101], v57 offset:0
    ds_read_b64_tr_b16 v[102:103], v57 offset:512
    ds_read_b64_tr_b16 v[104:105], v58 offset:0
    ds_read_b64_tr_b16 v[106:107], v58 offset:512
    ds_read_b64_tr_b16 v[108:109], v59 offset:0
    ds_read_b64_tr_b16 v[110:111], v59 offset:512
    s_waitcnt vmcnt(20)
    ds_read_b64_tr_b16 v[112:113], v56 offset:4096
    ds_read_b64_tr_b16 v[114:115], v56 offset:4608
    ds_read_b64_tr_b16 v[116:117], v57 offset:4096
    ds_read_b64_tr_b16 v[118:119], v57 offset:4608
    ds_read_b64_tr_b16 v[120:121], v58 offset:4096
    ds_read_b64_tr_b16 v[122:123], v58 offset:4608
    ds_read_b64_tr_b16 v[124:125], v59 offset:4096
    ds_read_b64_tr_b16 v[126:127], v59 offset:4608
    s_waitcnt lgkmcnt(8)
    v_mfma_f32_16x16x32_bf16 v[8:11], v[96:99], v[64:67], 0
    v_mfma_f32_16x16x32_bf16 v[12:15], v[100:103], v[64:67], 0
    v_mfma_f32_16x16x32_bf16 v[16:19], v[104:107], v[64:67], 0
    v_mfma_f32_16x16x32_bf16 v[20:23], v[108:111], v[64:67], 0
    s_waitcnt vmcnt(16)
    ds_read_b64_tr_b16 v[128:129], v56 offset:8192
    ds_read_b64_tr_b16 v[130:131], v56 offset:8704
    ds_read_b64_tr_b16 v[132:133], v57 offset:8192
    ds_read_b64_tr_b16 v[134:135], v57 offset:8704
    ds_read_b64_tr_b16 v[136:137], v58 offset:8192
    ds_read_b64_tr_b16 v[138:139], v58 offset:8704
    ds_read_b64_tr_b16 v[140:141], v59 offset:8192
    ds_read_b64_tr_b16 v[142:143], v59 offset:8704
    s_waitcnt lgkmcnt(8)
    v_mfma_f32_16x16x32_bf16 v[8:11], v[112:115], v[68:71], v[8:11]
    v_mfma_f32_16x16x32_bf16 v[12:15], v[116:119], v[68:71], v[12:15]
    v_mfma_f32_16x16x32_bf16 v[16:19], v[120:123], v[68:71], v[16:19]
    v_mfma_f32_16x16x32_bf16 v[20:23], v[124:127], v[68:71], v[20:23]
    s_waitcnt vmcnt(12)
    ds_read_b64_tr_b16 v[144:145], v56 offset:12288
    ds_read_b64_tr_b16 v[146:147], v56 offset:12800
    ds_read_b64_tr_b16 v[148:149], v57 offset:12288
    ds_read_b64_tr_b16 v[150:151], v57 offset:12800
    ds_read_b64_tr_b16 v[152:153], v58 offset:12288
    ds_read_b64_tr_b16 v[154:155], v58 offset:12800
    ds_read_b64_tr_b16 v[156:157], v59 offset:12288
    ds_read_b64_tr_b16 v[158:159], v59 offset:12800
    s_waitcnt lgkmcnt(8)
    v_mfma_f32_16x16x32_bf16 v[8:11], v[128:131], v[72:75], v[8:11]
    v_mfma_f32_16x16x32_bf16 v[12:15], v[132:135], v[72:75], v[12:15]
    v_mfma_f32_16x16x32_bf16 v[16:19], v[136:139], v[72:75], v[16:19]
    v_mfma_f32_16x16x32_bf16 v[20:23], v[140:143], v[72:75], v[20:23]
    s_waitcnt vmcnt(8)
    ds_read_b64_tr_b16 v[160:161], v56 offset:16384
    ds_read_b64_tr_b16 v[162:163], v56 offset:16896
    ds_read_b64_tr_b16 v[164:165], v57 offset:16384
    ds_read_b64_tr_b16 v[166:167], v57 offset:16896
    ds_read_b64_tr_b16 v[168:169], v58 offset:16384
    ds_read_b64_tr_b16 v[170:171], v58 offset:16896
    ds_read_b64_tr_b16 v[172:173], v59 offset:16384
    ds_read_b64_tr_b16 v[174:175], v59 offset:16896
    s_waitcnt lgkmcnt(8)
    v_mfma_f32_16x16x32_bf16 v[8:11], v[144:147], v[76:79], v[8:11]
    v_mfma_f32_16x16x32_bf16 v[12:15], v[148:151], v[76:79], v[12:15]
    v_mfma_f32_16x16x32_bf16 v[16:19], v[152:155], v[76:79], v[16:19]
    v_mfma_f32_16x16x32_bf16 v[20:23], v[156:159], v[76:79], v[20:23]
    s_waitcnt vmcnt(4)
    ds_read_b64_tr_b16 v[176:177], v56 offset:20480
    ds_read_b64_tr_b16 v[178:179], v56 offset:20992
    ds_read_b64_tr_b16 v[180:181], v57 offset:20480
    ds_read_b64_tr_b16 v[182:183], v57 offset:20992
    ds_read_b64_tr_b16 v[184:185], v58 offset:20480
    ds_read_b64_tr_b16 v[186:187], v58 offset:20992
    ds_read_b64_tr_b16 v[188:189], v59 offset:20480
    ds_read_b64_tr_b16 v[190:191], v59 offset:20992
    s_waitcnt lgkmcnt(8)
    v_mfma_f32_16x16x32_bf16 v[8:11], v[160:163], v[80:83], v[8:11]
    v_mfma_f32_16x16x32_bf16 v[12:15], v[164:167], v[80:83], v[12:15]
    v_mfma_f32_16x16x32_bf16 v[16:19], v[168:171], v[80:83], v[16:19]
    v_mfma_f32_16x16x32_bf16 v[20:23], v[172:175], v[80:83], v[20:23]
    s_waitcnt vmcnt(0)
    ds_read_b64_tr_b16 v[192:193], v56 offset:24576
    ds_read_b64_tr_b16 v[194:195], v56 offset:25088
    ds_read_b64_tr_b16 v[196:197], v57 offset:24576
    ds_read_b64_tr_b16 v[198:199], v57 offset:25088
    ds_read_b64_tr_b16 v[200:201], v58 offset:24576
    ds_read_b64_tr_b16 v[202:203], v58 offset:25088
    ds_read_b64_tr_b16 v[204:205], v59 offset:24576
    ds_read_b64_tr_b16 v[206:207], v59 offset:25088
    s_waitcnt lgkmcnt(8)
    v_mfma_f32_16x16x32_bf16 v[8:11], v[176:179], v[84:87], v[8:11]
    v_mfma_f32_16x16x32_bf16 v[12:15], v[180:183], v[84:87], v[12:15]
    v_mfma_f32_16x16x32_bf16 v[16:19], v[184:187], v[84:87], v[16:19]
    v_mfma_f32_16x16x32_bf16 v[20:23], v[188:191], v[84:87], v[20:23]
    s_waitcnt lgkmcnt(0)
    v_mfma_f32_16x16x32_bf16 v[8:11], v[192:195], v[88:91], v[8:11]
    v_mfma_f32_16x16x32_bf16 v[12:15], v[196:199], v[88:91], v[12:15]
    v_mfma_f32_16x16x32_bf16 v[16:19], v[200:203], v[88:91], v[16:19]
    v_mfma_f32_16x16x32_bf16 v[20:23], v[204:207], v[88:91], v[20:23]
    s_nop 6
    v_cndmask_b32 v8, v8, v12, vcc
    v_cndmask_b32 v9, v9, v13, vcc
    v_cndmask_b32 v10, v10, v14, vcc
    v_cndmask_b32 v11, v11, v15, vcc
    v_cndmask_b32 v8, v8, v16, s[44:45]
    v_cndmask_b32 v9, v9, v17, s[44:45]
    v_cndmask_b32 v10, v10, v18, s[44:45]
    v_cndmask_b32 v11, v11, v19, s[44:45]
    s_nop 0
    v_cndmask_b32 v8, v8, v20, s[46:47]
    v_cndmask_b32 v9, v9, v21, s[46:47]
    v_cndmask_b32 v10, v10, v22, s[46:47]
    v_cndmask_b32 v11, v11, v23, s[46:47]
    v_add_u32 v8, 32, v8
    v_add_u32 v9, 32, v9
    v_add_u32 v10, 32, v10
    v_add_u32 v11, 32, v11
    v_and_or_b32 v8, v8, s43, v7
    v_and_or_b32 v9, v9, s43, v7
    v_and_or_b32 v10, v10, s43, v7
    v_and_or_b32 v11, v11, s43, v7
    buffer_store_dwordx4 v[8:11], v60, s[56:59], s53 offen sc1
    s_barrier
    s_branch L_hb1
L_h123:
    s_waitcnt lgkmcnt(0)
    s_load_dword s7, s[30:31], 0
    s_mov_b32 s56, s30
    s_mov_b32 s57, s31
    s_mov_b32 s58, 4194304
    s_mov_b32 s59, 0x20000
    s_and_b32 s51, s2, 31
    s_lshl_b32 s51, s51, 12
    s_add_u32 s51, s51, 65536
    v_lshlrev_b32 v5, 4, v0
    v_lshlrev_b32 v6, 3, v0
    s_mov_b32 s43, 4294967232
    s_waitcnt lgkmcnt(0)
    s_add_u32 s7, s7, 1
    s_and_b32 s41, s7, 63
    s_barrier
    s_cmp_lg_u32 s3, 2
    s_cbranch_scc1 L_hb1
    s_mov_b64 s[80:81], -1
    s_mov_b64 s[82:83], -1
    s_mov_b64 s[84:85], -1
    s_mov_b64 s[86:87], -1
    s_mov_b32 s40, 1048576
L_pq:
    s_mov_b64 exec, s[80:81]
    s_cbranch_execz L_pq_s0
    buffer_load_dwordx4 v[8:11], v5, s[56:59], s51 offen offset:0 sc1
L_pq_s0:
    s_mov_b64 exec, s[82:83]
    s_cbranch_execz L_pq_s1
    buffer_load_dwordx4 v[12:15], v5, s[56:59], s51 offen offset:1024 sc1
L_pq_s1:
    s_mov_b64 exec, s[84:85]
    s_cbranch_execz L_pq_s2
    buffer_load_dwordx4 v[16:19], v5, s[56:59], s51 offen offset:2048 sc1
L_pq_s2:
    s_mov_b64 exec, s[86:87]
    s_cbranch_execz L_pq_s3
    buffer_load_dwordx4 v[20:23], v5, s[56:59], s51 offen offset:3072 sc1
L_pq_s3:
    s_sub_u32 s40, s40, 1
    s_cselect_b64 s[90:91], 0, -1
    s_mov_b64 exec, s[80:81]
    s_waitcnt vmcnt(0)
    v_xor_b32 v7, s41, v8
    v_bitop3_b32 v7, v9, s41, v7 bitop3:0xbe
    v_bitop3_b32 v7, v10, s41, v7 bitop3:0xbe
    v_bitop3_b32 v7, v11, s41, v7 bitop3:0xbe
    v_and_b32 v7, 63, v7
    v_cmp_ne_u32 s[80:81], 0, v7
    s_mov_b64 exec, s[82:83]
    v_xor_b32 v7, s41, v12
    v_bitop3_b32 v7, v13, s41, v7 bitop3:0xbe
    v_bitop3_b32 v7, v14, s41, v7 bitop3:0xbe
    v_bitop3_b32 v7, v15, s41, v7 bitop3:0xbe
    v_and_b32 v7, 63, v7
    v_cmp_ne_u32 s[82:83], 0, v7
    s_mov_b64 exec, s[84:85]
    v_xor_b32 v7, s41, v16
    v_bitop3_b32 v7, v17, s41, v7 bitop3:0xbe
    v_bitop3_b32 v7, v18, s41, v7 bitop3:0xbe
    v_bitop3_b32 v7, v19, s41, v7 bitop3:0xbe
    v_and_b32 v7, 63, v7
    v_cmp_ne_u32 s[84:85], 0, v7
    s_mov_b64 exec, s[86:87]
    v_xor_b32 v7, s41, v20
    v_bitop3_b32 v7, v21, s41, v7 bitop3:0xbe
    v_bitop3_b32 v7, v22, s41, v7 bitop3:0xbe
    v_bitop3_b32 v7, v23, s41, v7 bitop3:0xbe
    v_and_b32 v7, 63, v7
    v_cmp_ne_u32 s[86:87], 0, v7
    s_or_b64 s[88:89], s[80:81], s[82:83]
    s_or_b64 s[88:89], s[88:89], s[84:85]
    s_or_b64 s[88:89], s[88:89], s[86:87]
    s_and_b64 s[88:89], s[88:89], s[90:91]
    s_cbranch_scc1 L_pq
    s_mov_b64 exec, -1
    v_and_b32 v8, s43, v8
    v_and_b32 v9, s43, v9
    v_and_b32 v10, s43, v10
    v_and_b32 v11, s43, v11
    v_and_b32 v12, s43, v12
    v_and_b32 v13, s43, v13
    v_and_b32 v14, s43, v14
    v_and_b32 v15, s43, v15
    v_and_b32 v16, s43, v16
    v_and_b32 v17, s43, v17
    v_and_b32 v18, s43, v18
    v_and_b32 v19, s43, v19
    v_and_b32 v20, s43, v20
    v_and_b32 v21, s43, v21
    v_and_b32 v22, s43, v22
    v_and_b32 v23, s43, v23
    v_pk_add_f32 v[8:9], v[8:9], v[16:17]
    v_pk_add_f32 v[10:11], v[10:11], v[18:19]
    v_pk_add_f32 v[12:13], v[12:13], v[20:21]
    v_pk_add_f32 v[14:15], v[14:15], v[22:23]
    v_cvt_pk_bf16_f32 v8, v8, v9
    v_cvt_pk_bf16_f32 v9, v10, v11
    v_cvt_pk_bf16_f32 v10, v12, v13
    v_cvt_pk_bf16_f32 v11, v14, v15
    ds_write_b64 v6, v[8:9] offset:32256
    ds_write_b64 v6, v[10:11] offset:32768
    s_waitcnt lgkmcnt(0)
L_hb1:
    s_barrier
    s_setprio 0
    s_and_b32 s49, s5, 3
    s_andn2_b32 s5, s5, 3
    s_add_u32 s5, s5, s3
    s_lshl_b32 s6, s4, 5
    s_add_u32 s6, s6, s5
    s_mul_i32 s48, s4, 28
    s_min_u32 s51, s5, 27
    s_add_u32 s48, s48, s51
    s_mul_i32 s51, s6, 14336
    s_add_u32 s36, s16, s51
    s_addc_u32 s37, s17, 0
    s_sub_u32 s38, 3670016, s51
    s_mov_b32 s39, 0x20000
    s_mul_i32 s51, s48, 7168
    s_add_u32 s44, s24, s51
    s_addc_u32 s45, s25, 0
    s_sub_u32 s46, 1605632, s51
    s_cmp_lt_u32 s5, 28
    s_cselect_b32 s46, s46, 0
    s_mov_b32 s47, 0x20000
    s_lshl_b32 s51, s49, 8
    v_lshl_add_u32 v5, v2, 4, s51
    v_mul_u32_u24 v6, 1792, v3
    v_add_u32 v7, v5, v6
    v_add_u32 v5, v7, v6
    v_mov_b32 v24, 0
    v_mov_b32 v25, 0
    v_mov_b32 v26, 0
    v_mov_b32 v27, 0
    v_mov_b32 v28, 0
    v_mov_b32 v29, 0
    v_mov_b32 v30, 0
    v_mov_b32 v31, 0
    v_mov_b32 v32, 0
    v_mov_b32 v33, 0
    v_mov_b32 v34, 0
    v_mov_b32 v35, 0
    v_mov_b32 v36, 0
    v_mov_b32 v37, 0
    v_mov_b32 v38, 0
    v_mov_b32 v39, 0
    v_mov_b32 v40, 0
    v_mov_b32 v41, 0
    v_mov_b32 v42, 0
    v_mov_b32 v43, 0
    v_mov_b32 v44, 0
    v_mov_b32 v45, 0
    v_mov_b32 v46, 0
    v_mov_b32 v47, 0
    s_cmp_eq_u32 s49, 3
    s_cselect_b32 s50, 0x00ff00ff, -1
    s_mov_b32 exec_lo, s50
    s_mov_b32 exec_hi, s50
    buffer_load_dwordx4 v[24:27], v5, s[36:39], 0 offen offset:0 nt
    buffer_load_dwordx4 v[28:31], v5, s[36:39], 0 offen offset:896 nt
    buffer_load_dwordx4 v[32:35], v5, s[36:39], 0 offen offset:1792 nt
    buffer_load_dwordx4 v[36:39], v5, s[36:39], 0 offen offset:2688 nt
    buffer_load_dwordx4 v[40:43], v7, s[44:47], 0 offen offset:0 nt
    buffer_load_dwordx4 v[44:47], v7, s[44:47], 0 offen offset:896 nt
    s_mov_b64 exec, -1
    v_and_b32 v5, 1, v2
    v_lshlrev_b32 v5, 4, v5
    v_mov_b32 v19, 0xffff
    v_lshlrev_b32 v19, v5, v19
    v_bfe_u32 v5, v2, 1, 2
    v_cmp_eq_u32 vcc, 0, v5
    s_nop 1
    v_cndmask_b32 v16, 0, v19, vcc
    v_cmp_eq_u32 vcc, 1, v5
    s_nop 1
    v_cndmask_b32 v17, 0, v19, vcc
    v_cmp_eq_u32 vcc, 2, v5
    s_nop 1
    v_cndmask_b32 v18, 0, v19, vcc
    v_cmp_eq_u32 vcc, 3, v5
    s_nop 1
    v_cndmask_b32 v19, 0, v19, vcc
    v_and_b32 v5, 31, v0
    v_lshlrev_b32 v5, 4, v5
    s_lshl_b32 s51, s48, 9
    s_add_u32 s51, s51, 196608
    s_mov_b64 s[80:81], -1
    s_mov_b32 s40, 1048576
L_ph:
    s_mov_b64 exec, s[80:81]
    buffer_load_dwordx4 v[8:11], v5, s[56:59], s51 offen sc1
    s_sub_u32 s40, s40, 1
    s_cselect_b64 s[90:91], 0, -1
    s_waitcnt vmcnt(0)
    v_xor_b32 v7, s41, v8
    v_bitop3_b32 v7, v9, s41, v7 bitop3:0xbe
    v_bitop3_b32 v7, v10, s41, v7 bitop3:0xbe
    v_bitop3_b32 v7, v11, s41, v7 bitop3:0xbe
    v_and_b32 v7, 63, v7
    v_cmp_ne_u32 s[80:81], 0, v7
    s_and_b64 s[88:89], s[80:81], s[90:91]
    s_cbranch_scc1 L_ph
    s_mov_b64 exec, -1
    v_and_b32 v8, s43, v8
    v_and_b32 v9, s43, v9
    v_and_b32 v10, s43, v10
    v_and_b32 v11, s43, v11
    v_and_b32 v5, 1, v0
    v_lshlrev_b32 v5, 4, v5
    v_and_b32 v6, 6, v0
    v_lshl_add_u32 v5, v6, 5, v5
    s_lshl_b32 s51, s3, 8
    v_add_u32 v5, s51, v5
    v_add_f32_dpp v8, v8, v8 row_ror:8 row_mask:0xf bank_mask:0xf
    v_add_f32_dpp v9, v9, v9 row_ror:8 row_mask:0xf bank_mask:0xf
    v_add_f32_dpp v10, v10, v10 row_ror:8 row_mask:0xf bank_mask:0xf
    v_add_f32_dpp v11, v11, v11 row_ror:8 row_mask:0xf bank_mask:0xf
    v_cvt_pk_bf16_f32 v8, v8, v8
    v_cvt_pk_bf16_f32 v9, v9, v9
    v_cvt_pk_bf16_f32 v10, v10, v10
    v_cvt_pk_bf16_f32 v11, v11, v11
    v_and_b32 v8, 0xffff0000, v8
    v_and_b32 v9, 0xffff0000, v9
    v_and_b32 v10, 0xffff0000, v10
    v_and_b32 v11, 0xffff0000, v11
    v_mov_b32 v12, v8
    v_mov_b32 v13, v9
    v_mov_b32 v14, v10
    v_mov_b32 v15, v11
    s_nop 1
    v_permlane16_swap_b32 v8, v12
    v_permlane16_swap_b32 v9, v13
    v_permlane16_swap_b32 v10, v14
    v_permlane16_swap_b32 v11, v15
    s_nop 1
    v_mul_f32 v64, 0xbfb8aa3b, v8
    v_mul_f32 v65, 0xbfb8aa3b, v9
    v_mul_f32 v66, 0xbfb8aa3b, v10
    v_mul_f32 v67, 0xbfb8aa3b, v11
    v_exp_f32 v64, v64
    v_exp_f32 v65, v65
    v_exp_f32 v66, v66
    v_exp_f32 v67, v67
    v_add_f32 v64, 1.0, v64
    v_add_f32 v65, 1.0, v65
    v_add_f32 v66, 1.0, v66
    v_add_f32 v67, 1.0, v67
    v_rcp_f32 v64, v64
    v_rcp_f32 v65, v65
    v_rcp_f32 v66, v66
    v_rcp_f32 v67, v67
    v_mul_f32 v8, v64, v8
    v_mul_f32 v9, v65, v9
    v_mul_f32 v10, v66, v10
    v_mul_f32 v11, v67, v11
    v_cvt_pk_bf16_f32 v8, v8, v8
    v_cvt_pk_bf16_f32 v9, v9, v9
    v_cvt_pk_bf16_f32 v10, v10, v10
    v_cvt_pk_bf16_f32 v11, v11, v11
    v_and_b32 v8, 0xffff0000, v8
    v_and_b32 v9, 0xffff0000, v9
    v_and_b32 v10, 0xffff0000, v10
    v_and_b32 v11, 0xffff0000, v11
    v_mul_f32 v8, v8, v12
    v_mul_f32 v9, v9, v13
    v_mul_f32 v10, v10, v14
    v_mul_f32 v11, v11, v15
    v_cvt_pk_bf16_f32 v8, v8, v8
    v_cvt_pk_bf16_f32 v9, v9, v9
    v_cvt_pk_bf16_f32 v10, v10, v10
    v_cvt_pk_bf16_f32 v11, v11, v11
    ds_write_b128 v5, v[8:11] offset:33280
    s_waitcnt lgkmcnt(0)
    v_lshrrev_b32 v4, 3, v2
    v_lshlrev_b32 v5, 6, v4
    v_lshl_add_u32 v5, v3, 3, v5
    v_add_u32 v5, s51, v5
    ds_read_b64 v[8:9], v5 offset:33280
    ds_read_b64 v[10:11], v5 offset:33408
    s_and_b32 s41, s7, 1023
    s_mov_b32 s43, 4294966272
    s_waitcnt lgkmcnt(0) vmcnt(0)
    v_and_b32 v64, v8, v16
    v_and_b32 v65, v8, v17
    v_and_b32 v66, v8, v18
    v_and_b32 v67, v8, v19
    v_and_b32 v68, v9, v16
    v_and_b32 v69, v9, v17
    v_and_b32 v70, v9, v18
    v_and_b32 v71, v9, v19
    v_and_b32 v72, v10, v16
    v_and_b32 v73, v10, v17
    v_and_b32 v74, v10, v18
    v_and_b32 v75, v10, v19
    v_and_b32 v76, v11, v16
    v_and_b32 v77, v11, v17
    v_and_b32 v78, v11, v18
    v_and_b32 v79, v11, v19
    s_nop 1
    v_mfma_f32_16x16x32_bf16 v[48:51], v[64:67], v[40:43], 0
    v_mfma_f32_16x16x32_bf16 v[52:55], v[72:75], v[40:43], 0
    v_mfma_f32_16x16x32_bf16 v[48:51], v[68:71], v[44:47], v[48:51]
    v_mfma_f32_16x16x32_bf16 v[52:55], v[76:79], v[44:47], v[52:55]
    v_and_b32 v5, 7, v2
    v_lshl_add_u32 v4, v4, 6, v5
    s_lshl_b32 s51, s4, 4
    s_lshr_b32 s52, s5, 4
    s_add_u32 s51, s51, s52
    v_lshl_add_u32 v4, v4, 1, s51
    v_lshlrev_b32 v5, 4, v4
    v_lshlrev_b32 v6, 11, v2
    v_lshl_add_u32 v6, v3, 4, v6
    s_lshl_b32 s52, s4, 16
    s_lshl_b32 s53, s5, 6
    s_add_u32 s52, s52, s53
    s_add_u32 s52, s52, 524288
    s_add_u32 s62, s52, 32768
    s_and_b32 s54, s2, 31
    s_lshl_b32 s54, s54, 3
    s_lshr_b32 s55, s2, 5
    s_add_u32 s54, s54, s55
    s_lshr_b32 s94, s2, 3
    s_xor_b32 s95, s3, 3
    s_or_b32 s94, s94, s95
    s_lshl_b32 s95, s4, 2
    s_mov_b32 s42, 327680
    v_lshrrev_b32 v22, 2, v0
    v_and_b32 v8, 3, v0
    v_lshlrev_b32 v8, 4, v8
    v_lshl_add_u32 v61, v22, 12, v8
    v_lshl_add_u32 v22, v22, 6, v8
    s_lshl_b32 s48, s49, 17
    s_lshl_b32 s51, s3, 16
    s_add_u32 s48, s48, s51
    s_lshr_b32 s51, s6, 2
    s_lshl_b32 s51, s51, 6
    s_add_u32 s48, s48, s51
    s_add_u32 s48, s48, 1048576
    s_lshl_b32 s63, s4, 16
    s_lshl_b32 s51, s3, 10
    s_add_u32 s63, s63, s51
    s_and_b32 s51, s2, 24
    s_lshr_b32 s53, s2, 5
    s_add_u32 s51, s51, s53
    s_lshl_b32 s51, s51, 11
    s_add_u32 s63, s63, s51
    s_add_u32 s63, s63, 524288
    s_lshl_b32 s51, s3, 10
    v_lshl_add_u32 v23, v0, 4, s51
    v_add_u32 v62, s51, v23
    s_barrier
    s_barrier
    s_cmp_lg_u32 s3, 3
    s_cbranch_scc1 L_st
    v_lshlrev_b32 v7, 4, v0
    s_mov_b64 exec, 3
    ds_read_b128 v[8:11], v7 offset:34304
    ds_read_b128 v[12:15], v7 offset:34336
    s_lshl_b32 s55, s54, 5
    s_add_u32 s55, s55, 327680
    s_waitcnt lgkmcnt(0)
    v_max3_f32 v8, v8, v9, v10
    v_add_f32 v12, v12, v13
    v_add_f32 v14, v14, v15
    v_max_f32 v8, v8, v11
    v_add_f32 v9, v12, v14
    v_mov_b32 v10, s7
    v_mov_b32 v11, s7
    buffer_store_dwordx4 v[8:11], v7, s[56:59], s55 offen sc1
    s_mov_b64 exec, -1
L_st:
    s_mov_b32 s55, 331776
    s_barrier
    s_mov_b64 s[80:81], -1
    s_mov_b64 s[82:83], -1
    s_mov_b32 s40, 1048576
L_ps:
    s_mov_b64 exec, s[80:81]
    s_cbranch_execz L_ps_s0
    buffer_load_dwordx4 v[8:11], v5, s[56:59], s42 offen sc1
L_ps_s0:
    s_mov_b64 exec, s[82:83]
    s_cbranch_execz L_ps_s1
    buffer_load_dwordx4 v[12:15], v5, s[56:59], s55 offen sc1
L_ps_s1:
    s_sub_u32 s40, s40, 1
    s_cselect_b64 s[90:91], 0, -1
    s_mov_b64 exec, s[80:81]
    s_waitcnt vmcnt(0)
    v_xor_b32 v7, s7, v10
    v_bitop3_b32 v7, v11, s7, v7 bitop3:0xbe
    v_cmp_ne_u32 s[80:81], 0, v7
    s_mov_b64 exec, s[82:83]
    v_xor_b32 v7, s7, v14
    v_bitop3_b32 v7, v15, s7, v7 bitop3:0xbe
    v_cmp_ne_u32 s[82:83], 0, v7
    s_or_b64 s[88:89], s[80:81], s[82:83]
    s_and_b64 s[88:89], s[88:89], s[90:91]
    s_cbranch_scc1 L_ps
    s_mov_b64 exec, -1
    v_mov_b32 v10, v12
    v_mov_b32 v11, v13
    v_mov_b32 v12, v8
    v_mov_b32 v13, v10
    s_nop 0
    s_nop 0
    v_max_f32_dpp v12, v12, v12 row_half_mirror row_mask:0xf bank_mask:0xf
    v_max_f32_dpp v13, v13, v13 row_half_mirror row_mask:0xf bank_mask:0xf
    s_nop 0
    v_max_f32_dpp v12, v12, v12 quad_perm:[1,0,3,2] row_mask:0xf bank_mask:0xf
    v_max_f32_dpp v13, v13, v13 quad_perm:[1,0,3,2] row_mask:0xf bank_mask:0xf
    s_nop 0
    v_max_f32_dpp v12, v12, v12 quad_perm:[2,3,0,1] row_mask:0xf bank_mask:0xf
    v_max_f32_dpp v13, v13, v13 quad_perm:[2,3,0,1] row_mask:0xf bank_mask:0xf
    s_mov_b32 s55, 1035512379
    v_sub_f32 v8, v8, v12
    v_sub_f32 v10, v10, v13
    v_mul_f32 v8, s55, v8
    v_mul_f32 v10, s55, v10
    v_exp_f32 v8, v8
    v_exp_f32 v10, v10
    s_nop 0
    v_mul_f32 v9, v9, v8
    v_mul_f32 v11, v11, v10
    s_nop 0
    s_nop 0
    v_add_f32_dpp v9, v9, v9 row_half_mirror row_mask:0xf bank_mask:0xf
    v_add_f32_dpp v11, v11, v11 row_half_mirror row_mask:0xf bank_mask:0xf
    s_nop 0
    v_add_f32_dpp v9, v9, v9 quad_perm:[1,0,3,2] row_mask:0xf bank_mask:0xf
    v_add_f32_dpp v11, v11, v11 quad_perm:[1,0,3,2] row_mask:0xf bank_mask:0xf
    s_nop 0
    v_add_f32_dpp v9, v9, v9 quad_perm:[2,3,0,1] row_mask:0xf bank_mask:0xf
    v_add_f32_dpp v11, v11, v11 quad_perm:[2,3,0,1] row_mask:0xf bank_mask:0xf
    v_rcp_f32 v9, v9
    v_rcp_f32 v11, v11
    s_nop 0
    v_mul_f32 v20, v8, v9
    v_mul_f32 v21, v10, v11
    s_mov_b32 s84, s28
    s_mov_b32 s85, s29
    s_mov_b32 s86, 256
    s_mov_b32 s87, 0x20000
    s_lshl_b32 s88, s4, 5
    s_lshl_b32 s89, s4, 12
    s_add_u32 s89, s89, 2048
    v_mbcnt_lo_u32_b32 v57, -1, 0
    v_lshlrev_b32 v57, 7, v57
    v_mov_b32 v58, 1
    v_mov_b32 v59, s7
    s_setprio 3
    s_barrier
    s_cmp_lg_u32 s3, 3
    s_cbranch_scc1 L_nb
    s_mov_b64 exec, 1
    buffer_atomic_add v58, off, s[84:87], s88 sc0 sc1
    s_waitcnt vmcnt(0)
    v_readfirstlane_b32 s88, v58
    s_and_b32 s88, s88, 31
    s_cmp_lg_u32 s88, 31
    s_cbranch_scc1 L_na
    s_mov_b32 exec_lo, 0x1
    buffer_store_dword v59, v57, s[56:59], s89 offen offset:2048 sc1
L_na:
    s_mov_b64 exec, -1
L_nb:
    s_setprio 3
    s_barrier
    s_cmp_gt_u32 s3, 1
    s_cbranch_scc1 L_t3
    ds_read_b128 v[64:67], v23 offset:34816
    ds_read_b128 v[68:71], v23 offset:36864
    ds_read_b128 v[72:75], v23 offset:38912
    ds_read_b128 v[76:79], v23 offset:40960
    s_waitcnt lgkmcnt(2)
    v_pk_add_f32 v[64:65], v[64:65], v[68:69]
    v_pk_add_f32 v[66:67], v[66:67], v[70:71]
    s_waitcnt lgkmcnt(0)
    v_pk_add_f32 v[72:73], v[72:73], v[76:77]
    v_pk_add_f32 v[74:75], v[74:75], v[78:79]
    v_mov_b32 v8, s41
    v_pk_add_f32 v[64:65], v[64:65], v[72:73]
    v_pk_add_f32 v[66:67], v[66:67], v[74:75]
    v_and_or_b32 v64, v64, s43, v8
    v_and_or_b32 v65, v65, s43, v8
    v_and_or_b32 v66, v66, s43, v8
    v_and_or_b32 v67, v67, s43, v8
    buffer_store_dwordx4 v[64:67], v22, s[56:59], s63 offen sc1
L_t3:
    s_lshr_b32 s88, s2, 3
    s_and_b32 s88, s88, 0
    s_lshl_b32 s88, s88, 7
    s_add_u32 s88, s88, s89
    v_mov_b32 v5, s88
    s_movk_i32 s40, 2048
L_g1:
    buffer_load_dword v8, v5, s[56:59], 0 offen offset:2048 sc1
    s_sub_u32 s40, s40, 1
    s_cbranch_scc1 L_g1_x
    s_waitcnt vmcnt(0)
    v_cmp_ne_u32 vcc, s7, v8
    s_cbranch_vccnz L_g1
L_g1_x:
    s_mov_b64 s[80:81], -1
    s_mov_b64 s[82:83], -1
    s_mov_b32 s40, 1048576
L_p1:
    s_mov_b64 exec, s[80:81]
    s_cbranch_execz L_p1_s0
    buffer_load_dwordx4 v[8:11], v6, s[56:59], s52 offen sc1
L_p1_s0:
    s_mov_b64 exec, s[82:83]
    s_cbranch_execz L_p1_s1
    buffer_load_dwordx4 v[12:15], v6, s[56:59], s62 offen sc1
L_p1_s1:
    s_sub_u32 s40, s40, 1
    s_cselect_b64 s[90:91], 0, -1
    s_mov_b64 exec, s[80:81]
    s_waitcnt vmcnt(0)
    v_xor_b32 v5, s41, v8
    v_bitop3_b32 v5, v9, s41, v5 bitop3:0xbe
    v_bitop3_b32 v5, v10, s41, v5 bitop3:0xbe
    v_bitop3_b32 v5, v11, s41, v5 bitop3:0xbe
    v_and_b32 v5, 1023, v5
    v_cmp_ne_u32 s[80:81], 0, v5
    s_mov_b64 exec, s[82:83]
    v_xor_b32 v5, s41, v12
    v_bitop3_b32 v5, v13, s41, v5 bitop3:0xbe
    v_bitop3_b32 v5, v14, s41, v5 bitop3:0xbe
    v_bitop3_b32 v5, v15, s41, v5 bitop3:0xbe
    v_and_b32 v5, 1023, v5
    v_cmp_ne_u32 s[82:83], 0, v5
    s_or_b64 s[88:89], s[80:81], s[82:83]
    s_and_b64 s[88:89], s[88:89], s[90:91]
    s_cbranch_scc1 L_p1
    s_mov_b64 exec, -1
    s_cmp_lg_u32 s94, 0
    s_cbranch_scc1 L_ng2
    s_mov_b64 exec, 0x1
    v_mov_b32 v5, s7
    buffer_store_dword v5, v57, s[56:59], s95 offen offset:2304 sc1
    s_mov_b64 exec, -1
L_ng2:
    v_and_b32 v8, s43, v8
    v_and_b32 v9, s43, v9
    v_and_b32 v10, s43, v10
    v_and_b32 v11, s43, v11
    v_and_b32 v12, s43, v12
    v_and_b32 v13, s43, v13
    v_and_b32 v14, s43, v14
    v_and_b32 v15, s43, v15
    v_mul_f32 v8, v8, v20
    v_mul_f32 v9, v9, v20
    v_mul_f32 v10, v10, v20
    v_mul_f32 v11, v11, v20
    v_mul_f32 v12, v12, v21
    v_mul_f32 v13, v13, v21
    v_mul_f32 v14, v14, v21
    v_mul_f32 v15, v15, v21
    v_add_f32_dpp v8, v8, v8 row_half_mirror row_mask:0xf bank_mask:0xf
    v_add_f32_dpp v9, v9, v9 row_half_mirror row_mask:0xf bank_mask:0xf
    v_add_f32_dpp v10, v10, v10 row_half_mirror row_mask:0xf bank_mask:0xf
    v_add_f32_dpp v11, v11, v11 row_half_mirror row_mask:0xf bank_mask:0xf
    v_add_f32_dpp v12, v12, v12 row_half_mirror row_mask:0xf bank_mask:0xf
    v_add_f32_dpp v13, v13, v13 row_half_mirror row_mask:0xf bank_mask:0xf
    v_add_f32_dpp v14, v14, v14 row_half_mirror row_mask:0xf bank_mask:0xf
    v_add_f32_dpp v15, v15, v15 row_half_mirror row_mask:0xf bank_mask:0xf
    v_add_f32_dpp v8, v8, v8 quad_perm:[1,0,3,2] row_mask:0xf bank_mask:0xf
    v_add_f32_dpp v9, v9, v9 quad_perm:[1,0,3,2] row_mask:0xf bank_mask:0xf
    v_add_f32_dpp v10, v10, v10 quad_perm:[1,0,3,2] row_mask:0xf bank_mask:0xf
    v_add_f32_dpp v11, v11, v11 quad_perm:[1,0,3,2] row_mask:0xf bank_mask:0xf
    v_add_f32_dpp v12, v12, v12 quad_perm:[1,0,3,2] row_mask:0xf bank_mask:0xf
    v_add_f32_dpp v13, v13, v13 quad_perm:[1,0,3,2] row_mask:0xf bank_mask:0xf
    v_add_f32_dpp v14, v14, v14 quad_perm:[1,0,3,2] row_mask:0xf bank_mask:0xf
    v_add_f32_dpp v15, v15, v15 quad_perm:[1,0,3,2] row_mask:0xf bank_mask:0xf
    v_add_f32_dpp v8, v8, v8 quad_perm:[2,3,0,1] row_mask:0xf bank_mask:0xf
    v_add_f32_dpp v9, v9, v9 quad_perm:[2,3,0,1] row_mask:0xf bank_mask:0xf
    v_add_f32_dpp v10, v10, v10 quad_perm:[2,3,0,1] row_mask:0xf bank_mask:0xf
    v_add_f32_dpp v11, v11, v11 quad_perm:[2,3,0,1] row_mask:0xf bank_mask:0xf
    v_add_f32_dpp v12, v12, v12 quad_perm:[2,3,0,1] row_mask:0xf bank_mask:0xf
    v_add_f32_dpp v13, v13, v13 quad_perm:[2,3,0,1] row_mask:0xf bank_mask:0xf
    v_add_f32_dpp v14, v14, v14 quad_perm:[2,3,0,1] row_mask:0xf bank_mask:0xf
    v_add_f32_dpp v15, v15, v15 quad_perm:[2,3,0,1] row_mask:0xf bank_mask:0xf
    v_cvt_pk_bf16_f32 v8, v8, v8
    v_cvt_pk_bf16_f32 v9, v9, v9
    v_cvt_pk_bf16_f32 v10, v10, v10
    v_cvt_pk_bf16_f32 v11, v11, v11
    v_cvt_pk_bf16_f32 v12, v12, v12
    v_cvt_pk_bf16_f32 v13, v13, v13
    v_cvt_pk_bf16_f32 v14, v14, v14
    v_cvt_pk_bf16_f32 v15, v15, v15
    v_and_b32 v80, v8, v16
    v_and_b32 v81, v8, v17
    v_and_b32 v82, v8, v18
    v_and_b32 v83, v8, v19
    v_and_b32 v84, v12, v16
    v_and_b32 v85, v12, v17
    v_and_b32 v86, v12, v18
    v_and_b32 v87, v12, v19
    v_mfma_f32_16x16x32_bf16 v[48:51], v[80:83], v[24:27], v[48:51]
    v_and_b32 v88, v9, v16
    v_and_b32 v89, v9, v17
    v_and_b32 v90, v9, v18
    v_and_b32 v91, v9, v19
    v_mfma_f32_16x16x32_bf16 v[52:55], v[84:87], v[24:27], v[52:55]
    v_and_b32 v92, v13, v16
    v_and_b32 v93, v13, v17
    v_and_b32 v94, v13, v18
    v_and_b32 v95, v13, v19
    v_mfma_f32_16x16x32_bf16 v[48:51], v[88:91], v[28:31], v[48:51]
    v_and_b32 v96, v10, v16
    v_and_b32 v97, v10, v17
    v_and_b32 v98, v10, v18
    v_and_b32 v99, v10, v19
    v_mfma_f32_16x16x32_bf16 v[52:55], v[92:95], v[28:31], v[52:55]
    v_and_b32 v100, v14, v16
    v_and_b32 v101, v14, v17
    v_and_b32 v102, v14, v18
    v_and_b32 v103, v14, v19
    v_mfma_f32_16x16x32_bf16 v[48:51], v[96:99], v[32:35], v[48:51]
    v_and_b32 v104, v11, v16
    v_and_b32 v105, v11, v17
    v_and_b32 v106, v11, v18
    v_and_b32 v107, v11, v19
    v_mfma_f32_16x16x32_bf16 v[52:55], v[100:103], v[32:35], v[52:55]
    v_and_b32 v108, v15, v16
    v_and_b32 v109, v15, v17
    v_and_b32 v110, v15, v18
    v_and_b32 v111, v15, v19
    v_mfma_f32_16x16x32_bf16 v[48:51], v[104:107], v[36:39], v[48:51]
    s_nop 1
    v_mfma_f32_16x16x32_bf16 v[52:55], v[108:111], v[36:39], v[52:55]
    v_mov_b32 v8, s41
    s_nop 5
    ds_write_b128 v62, v[48:51] offset:0
    ds_write_b128 v62, v[52:55] offset:1024
    s_waitcnt lgkmcnt(0)
    s_barrier
    s_cmp_gt_u32 s3, 1
    s_cbranch_scc1 L_fin
    ds_read_b128 v[64:67], v23 offset:0
    ds_read_b128 v[68:71], v23 offset:2048
    ds_read_b128 v[72:75], v23 offset:4096
    ds_read_b128 v[76:79], v23 offset:6144
    s_mov_b32 exec_lo, s50
    s_mov_b32 exec_hi, s50
    s_waitcnt lgkmcnt(2)
    v_pk_add_f32 v[64:65], v[64:65], v[68:69]
    v_pk_add_f32 v[66:67], v[66:67], v[70:71]
    s_waitcnt lgkmcnt(0)
    v_pk_add_f32 v[72:73], v[72:73], v[76:77]
    v_pk_add_f32 v[74:75], v[74:75], v[78:79]
    v_pk_add_f32 v[64:65], v[64:65], v[72:73]
    v_pk_add_f32 v[66:67], v[66:67], v[74:75]
    v_and_or_b32 v64, v64, s43, v8
    v_and_or_b32 v65, v65, s43, v8
    v_and_or_b32 v66, v66, s43, v8
    v_and_or_b32 v67, v67, s43, v8
    buffer_store_dwordx4 v[64:67], v61, s[56:59], s48 offen sc1
    s_endpgm
L_codeend:
.section .rodata,"a"
.p2align 6
.amdhsa_kernel parallel_sum__sliding_block_cached__swiglu_ffn__decode_kernel
  .amdhsa_next_free_vgpr 256
  .amdhsa_next_free_sgpr 96
  .amdhsa_accum_offset 256
  .amdhsa_group_segment_fixed_size 0
  .amdhsa_kernarg_size 96
  .amdhsa_user_sgpr_count 2
  .amdhsa_user_sgpr_kernarg_segment_ptr 1
  .amdhsa_system_sgpr_workgroup_id_x 1
.end_amdhsa_kernel
```
